```python
import torch

def _softmax(x, axis=-1):
    return torch.softmax(x, dim=axis)
def _gelu(x):
    return torch.nn.functional.gelu(x, approximate="tanh")
def _silu(x):
    return torch.nn.functional.silu(x)
def _sigmoid(x):
    return torch.sigmoid(x)
def _layernorm(x, axis=-1, eps=1e-5):
    m = x.mean(dim=axis, keepdim=True)
    v = x.var(dim=axis, keepdim=True, unbiased=False)
    return (x - m) / torch.sqrt(v + eps)
def _scatter_add(tgt, idx, src, axis=0):
    return tgt.clone().index_add_(axis, idx, src)
def _segment_sum(src, seg, n):
    out = torch.zeros((n,) + src.shape[1:], dtype=src.dtype)
    return out.index_add_(0, seg, src)
def _pad(x, pw):
    flat = tuple(v for pair in reversed(pw) for v in pair)
    return torch.nn.functional.pad(x, flat)

kernel_name = 'concat_heads__grouped_kv_mqa__sliding_local_dilated__prompt'

def setup_inputs():

    _w = (lambda a: (lambda t: t.to(torch.bfloat16) if t.is_floating_point() else t)(torch.as_tensor(a)))
    def _A_setup():
        B, S, D, H = 1, 2048, 512, 32
        Dh = D // H
        return {
            "x": _w((lambda *s: torch.randn(*s, dtype=torch.bfloat16) * 0.05)(B, S, D)),
            "wq": _w((lambda *s: torch.randn(*s, dtype=torch.bfloat16) * 3.2)(D, H * Dh)),
            "wk": _w((lambda *s: torch.randn(*s, dtype=torch.bfloat16) * 3.2)(D, Dh)),
            "wv": _w((lambda *s: torch.randn(*s, dtype=torch.bfloat16) * 1.6)(D, Dh)),
            "wo": _w((lambda *s: torch.randn(*s, dtype=torch.bfloat16) * 1.6)(H * Dh, D)),
        }
    _A_in = _A_setup()

    def _B_setup():
        B, S, D = 1, 2048, 512
        return {
            "x": _w((lambda *s: torch.randn(*s, dtype=torch.bfloat16) * 0.1)(B, S, D)),
            "wqkv": _w((lambda *s: torch.randn(*s, dtype=torch.bfloat16) * 0.8)(D, 3 * D)),
            "wo": _w((lambda *s: torch.randn(*s, dtype=torch.bfloat16) * 0.8)(D, D)),
        }
    _B_in = _B_setup()

    return {
        "A_x": _A_in["x"],
        "A_wq": _A_in["wq"],
        "A_wk": _A_in["wk"],
        "A_wv": _A_in["wv"],
        "A_wo": _A_in["wo"],
        "B_x": _B_in["x"],
        "B_wqkv": _B_in["wqkv"],
        "B_wo": _B_in["wo"],
    }

def reference(A_x, A_wq, A_wk, A_wv, A_wo, B_x, B_wqkv, B_wo):
    def _A_ref(x, wq, wk, wv, wo):
        B, S, D = x.shape
        H = 32
        Dh = D // H
        q = (lambda x, *d: x.permute(*d))((x @ wq).reshape(B, S, H, Dh), 0, 2, 1, 3)
        k = x @ wk
        v = x @ wv
        scores = torch.einsum("bhqd,bkd->bhqk", q, k) * (Dh ** -0.5)
        p = _softmax(scores, axis=-1)
        o = torch.einsum("bhqk,bkd->bhqd", p, v)
        return (lambda x, *d: x.permute(*d))(o, 0, 2, 1, 3).reshape(B, S, H * Dh) @ wo

    def _B_ref(x, wqkv, wo):
        B, S, D = x.shape
        H = 32; Dh = D // H
        W, dil = 8, 2
        qkv = (lambda x, *d: x.permute(*d))((x @ wqkv).reshape(B, S, 3, H, Dh), 2, 0, 3, 1, 4)
        q, k, v = qkv[0], qkv[1], qkv[2]
        scale = Dh ** -0.5
        pos = torch.arange(S)
        off = torch.arange(W) * dil
        idx = pos[:, None] - off[None, :]
        mask = idx >= 0
        idx_c = torch.where(mask, idx, 0).reshape(-1)
        kg = k[:, :, idx_c, :].reshape(B, H, S, W, Dh)
        vg = v[:, :, idx_c, :].reshape(B, H, S, W, Dh)
        logits = torch.einsum("bhsd,bhswd->bhsw", q, kg) * scale
        logits = torch.where(mask[None, None, :, :], logits, -1e9)
        attn = _softmax(logits, axis=-1)
        o = torch.einsum("bhsw,bhswd->bhsd", attn, vg)
        return (lambda x, *d: x.permute(*d))(o, 0, 2, 1, 3).reshape(B, S, D) @ wo

    a = _A_ref(A_x, A_wq, A_wk, A_wv, A_wo)
    b = _B_ref(B_x, B_wqkv, B_wo)
    return torch.concatenate([a, b], axis=-1)
```

```asm
; @launch grid=(256,1,1) block=(768,1,1) lds=163840
.amdgcn_target "amdgcn-amd-amdhsa--gfx950"
.text
.globl concat_heads__grouped_kv_mqa__sliding_local_dilated__prompt_kernel
.p2align 8
.type concat_heads__grouped_kv_mqa__sliding_local_dilated__prompt_kernel,@function
concat_heads__grouped_kv_mqa__sliding_local_dilated__prompt_kernel:
    s_cmp_ge_u32 s2, 256
    s_cbranch_scc1 L_end
    s_and_b32 s92, s2, 8
    s_add_u32 s92, s92, 16
    s_load_dwordx2 s[32:33], s[0:1], 0
    s_load_dwordx2 s[36:37], s[0:1], 8
    s_load_dwordx2 s[64:65], s[0:1], 80
    s_load_dwordx2 s[40:41], s[0:1], s92
    v_lshrrev_b32 v1, 6, v0
    v_and_b32 v0, 63, v0
    s_lshr_b32 s93, s2, 3
    v_readfirstlane_b32 s3, v1
    s_and_b32 s92, s2, 7
    s_lshl_b32 s101, s92, 5
    s_add_u32 s101, s101, s93
    s_and_b32 s79, s3, 3
    s_cmp_lt_u32 s3, 8
    s_cbranch_scc1 L_nopf
    s_getpc_b64 s[94:95]
L_pc:
    s_lshl_b32 s92, s93, 2
    s_add_u32 s92, s92, s79
    s_and_b32 s92, s92, 31
    s_lshl_b32 s92, s92, 10
    v_lshl_add_u32 v2, v0, 7, s92
    v_min_u32 v2, L_codeend-L_pc-4, v2
    s_mov_b64 exec, 0xff
    global_load_dword v167, v2, s[94:95]
    s_mov_b64 exec, -1
L_nopf:
    s_lshr_b32 s72, s101, 3
    s_and_b32 s73, s101, 7
    s_lshr_b32 s74, s101, 4
    s_and_b32 s75, s101, 15
    s_lshr_b32 s76, s73, 1
    s_and_b32 s77, s73, 1
    s_mov_b32 s100, 0
    s_mov_b32 s34, 0x200000
    s_mov_b32 s35, 0x20000
    s_mov_b32 s42, 0x4000
    s_mov_b32 s43, 0x20000
    s_mov_b32 s38, 0x80000
    s_mov_b32 s39, 0x20000
    s_mov_b32 s66, 0x1000000
    s_mov_b32 s67, 0x20000
    s_cmp_ge_u32 s3, 8
    s_cbranch_scc1 L_q
    s_cmp_ge_u32 s3, 4
    s_cbranch_scc1 L_aux
    s_setprio 3
    v_lshrrev_b32 v12, 4, v0
    v_and_b32 v8, 15, v0
    v_xor_b32 v8, v8, v12
    v_lshlrev_b32 v8, 4, v8
    v_lshl_add_u32 v8, v12, 10, v8
    v_xor_b32 v9, 64, v8
    v_xor_b32 v10, 128, v8
    v_xor_b32 v11, 192, v8
    v_lshlrev_b32 v12, 4, v0
    s_add_u32 s95, s72, s79
    s_and_b32 s95, s95, 3
    s_lshr_b32 s93, s101, 1
    s_lshl_b32 s93, s93, 14
    s_lshl_b32 s94, s95, 8
    s_add_u32 s93, s93, s94
    s_lshl_b32 s80, s79, 15
    s_lshl_b32 s94, s76, 12
    s_add_u32 s80, s80, s94
    s_lshl_b32 s81, s79, 12
    s_add_u32 s81, s81, 131072
    s_lshl_b32 s95, s95, 12
    s_waitcnt lgkmcnt(0)
    s_add_u32 m0, s80, 0
    s_add_u32 s92, s93, 0
    buffer_load_dwordx4 v8, s[32:35], s92 offen nt lds
    s_add_u32 m0, s81, 0
    s_add_u32 s92, s95, 0
    buffer_load_dwordx4 v12, s[40:43], s92 offen lds
    s_add_u32 m0, s80, 1024
    s_add_u32 s92, s93, 4096
    buffer_load_dwordx4 v9, s[32:35], s92 offen nt lds
    s_add_u32 m0, s81, 1024
    s_add_u32 s92, s95, 1024
    buffer_load_dwordx4 v12, s[40:43], s92 offen lds
    s_add_u32 m0, s80, 2048
    s_add_u32 s92, s93, 8192
    buffer_load_dwordx4 v10, s[32:35], s92 offen nt lds
    s_add_u32 m0, s81, 2048
    s_add_u32 s92, s95, 2048
    buffer_load_dwordx4 v12, s[40:43], s92 offen lds
    s_add_u32 m0, s80, 3072
    s_add_u32 s92, s93, 12288
    buffer_load_dwordx4 v11, s[32:35], s92 offen nt lds
    s_add_u32 m0, s81, 3072
    s_add_u32 s92, s95, 3072
    buffer_load_dwordx4 v12, s[40:43], s92 offen lds
    s_mov_b32 s99, 5373952
    s_load_dword s99, s[64:65], s99
    s_barrier
    v_mov_b32 v5, 160256
    v_mov_b32 v6, 1
    v_and_b32 v2, 15, v0
    v_lshrrev_b32 v3, 4, v0
    v_xor_b32 v4, v2, v3
    v_lshlrev_b32 v4, 4, v4
    v_lshl_add_u32 v4, v2, 8, v4
    v_add_u32 v8, s80, v4
    v_xor_b32 v9, 64, v8
    v_xor_b32 v10, 128, v8
    v_xor_b32 v11, 192, v8
    v_bfe_u32 v4, v0, 2, 2
    v_lshl_add_u32 v4, v3, 3, v4
    v_lshlrev_b32 v4, 5, v4
    v_and_b32 v13, 3, v0
    v_lshl_add_u32 v4, v13, 3, v4
    v_add_u32 v13, s81, v4
    v_add_u32 v14, s81, v12
    s_lshl_b32 s92, s79, 2
    v_add_u32 v15, s92, v5
    s_lshl_b32 s92, s72, 11
    s_lshr_b32 s93, s76, 1
    s_lshl_b32 s93, s93, 10
    s_and_b32 s94, s76, 1
    s_lshl_b32 s94, s94, 8
    s_add_u32 s93, s93, s94
    s_add_u32 s93, s93, 5242880
    s_lshl_b32 s94, s76, 9
    s_add_u32 s94, s94, 5308416
    s_cmp_eq_u32 s77, 0
    s_cselect_b32 s93, s93, s94
    s_cselect_b32 s94, 9, 8
    s_add_u32 s96, s92, s93
    v_and_b32 v4, 1, v3
    v_lshlrev_b32 v4, s94, v4
    v_lshl_add_u32 v20, v2, 4, v4
    s_lshl_b32 s92, s77, 28
    s_add_u32 s92, s92, 0x3f800000
    v_mov_b32 v22, s92
    s_lshl_b32 s97, s101, 7
    s_add_u32 s97, s97, 5505024
    s_waitcnt lgkmcnt(0)
    s_add_u32 s99, s99, 1
    s_mul_i32 s71, s99, 0x9e3779b1
    s_waitcnt vmcnt(0)
    ds_read_b128 v[32:35], v8
    ds_read_b64_tr_b16 v[48:49], v13 offset:0
    ds_read_b64_tr_b16 v[50:51], v13 offset:128
    ds_read_b128 v[36:39], v9
    ds_read_b64_tr_b16 v[52:53], v13 offset:1024
    ds_read_b64_tr_b16 v[54:55], v13 offset:1152
    ds_read_b128 v[40:43], v10
    ds_read_b64_tr_b16 v[56:57], v13 offset:2048
    ds_read_b64_tr_b16 v[58:59], v13 offset:2176
    ds_read_b128 v[44:47], v11
    ds_read_b64_tr_b16 v[60:61], v13 offset:3072
    ds_read_b64_tr_b16 v[62:63], v13 offset:3200
    s_mov_b64 exec, 1
    ds_add_u32 v15, v6 offset:32
    s_mov_b64 exec, -1
    s_cmp_lg_u32 s77, 0
    s_cbranch_scc1 L_kv_v
    s_waitcnt lgkmcnt(10)
    v_mfma_f32_16x16x32_bf16 v[24:27], v[48:51], v[32:35], 0
    s_waitcnt lgkmcnt(7)
    v_mfma_f32_16x16x32_bf16 v[24:27], v[52:55], v[36:39], v[24:27]
    s_waitcnt lgkmcnt(4)
    v_mfma_f32_16x16x32_bf16 v[24:27], v[56:59], v[40:43], v[24:27]
    s_waitcnt lgkmcnt(1)
    v_mfma_f32_16x16x32_bf16 v[24:27], v[60:63], v[44:47], v[24:27]
    s_branch L_kv_d
L_kv_v:
    s_waitcnt lgkmcnt(10)
    v_mfma_f32_16x16x32_bf16 v[24:27], v[32:35], v[48:51], 0
    s_waitcnt lgkmcnt(7)
    v_mfma_f32_16x16x32_bf16 v[24:27], v[36:39], v[52:55], v[24:27]
    s_waitcnt lgkmcnt(4)
    v_mfma_f32_16x16x32_bf16 v[24:27], v[40:43], v[56:59], v[24:27]
    s_waitcnt lgkmcnt(1)
    v_mfma_f32_16x16x32_bf16 v[24:27], v[44:47], v[60:63], v[24:27]
L_kv_d:
    s_cmp_eq_u32 s79, 0
    s_cbranch_scc1 L_kv_0
    s_nop 0
    s_nop 0
    s_nop 0
    s_nop 0
    s_nop 0
    s_nop 0
    ds_write_b128 v14, v[24:27]
    s_mov_b64 exec, 1
    ds_add_u32 v5, v6 offset:0
    s_mov_b64 exec, -1
    s_branch L_h2
L_kv_0:
L_poll_1:
    ds_read_b32 v7, v5 offset:0
    s_waitcnt lgkmcnt(0)
    v_readfirstlane_b32 s98, v7
    s_cmp_ge_u32 s98, 3
    s_cbranch_scc1 L_poll_1_d
    s_sleep 0
    s_add_u32 s100, s100, 1
    s_cmp_lt_u32 s100, 60000
    s_cbranch_scc1 L_poll_1
L_poll_1_d:
    ds_read_b128 v[36:39], v14 offset:4096
    ds_read_b128 v[40:43], v14 offset:8192
    ds_read_b128 v[44:47], v14 offset:12288
    s_waitcnt lgkmcnt(1)
    v_pk_add_f32 v[36:37], v[36:37], v[40:41]
    v_pk_add_f32 v[38:39], v[38:39], v[42:43]
    s_waitcnt lgkmcnt(0)
    v_pk_add_f32 v[24:25], v[24:25], v[44:45]
    v_pk_add_f32 v[26:27], v[26:27], v[46:47]
    v_pk_add_f32 v[24:25], v[24:25], v[36:37]
    v_pk_add_f32 v[26:27], v[26:27], v[38:39]
    v_pk_mul_f32 v[24:25], v[24:25], v[22:23] op_sel_hi:[1,0]
    v_pk_mul_f32 v[26:27], v[26:27], v[22:23] op_sel_hi:[1,0]
    v_cvt_pk_bf16_f32 v28, v24, v25
    v_cvt_pk_bf16_f32 v29, v26, v27
    s_nop 0
    s_nop 0
    v_permlane32_swap_b32 v28, v30
    v_permlane32_swap_b32 v29, v31
    s_mov_b32 exec_hi, 0
    s_nop 0
    buffer_store_dwordx4 v[28:31], v20, s[64:67], s96 offen sc1
    s_mov_b64 exec, -1
    s_mov_b64 exec, 1
    ds_add_u32 v5, v6 offset:12
    s_mov_b64 exec, -1
    s_mov_b64 exec, 1
    ds_add_u32 v5, v6 offset:0
    s_mov_b64 exec, -1
    s_waitcnt vmcnt(0)
    v_mov_b32 v2, 0
    v_mov_b32 v3, s71
    s_mov_b64 exec, 1
    buffer_store_dword v3, v2, s[64:67], s97 offen sc1
    s_mov_b64 exec, -1
    s_branch L_h2
L_aux:
    s_lshl_b32 s92, s3, 8
    s_add_u32 m0, s92, 159744
    v_mov_b32 v2, 0
    ds_write_addtid_b32 v2
    v_lshrrev_b32 v12, 4, v0
    v_and_b32 v8, 15, v0
    v_xor_b32 v8, v8, v12
    v_lshlrev_b32 v8, 4, v8
    v_lshl_add_u32 v8, v12, 10, v8
    s_lshl_b32 s92, s79, 6
    v_xor_b32 v8, s92, v8
    v_lshrrev_b32 v2, 3, v0
    v_bfe_u32 v3, v0, 4, 1
    v_lshlrev_b32 v3, 2, v3
    v_and_b32 v4, 7, v0
    v_xor_b32 v4, v4, v3
    v_lshlrev_b32 v4, 4, v4
    v_lshl_add_u32 v12, v2, 10, v4
    s_lshl_b32 s80, s79, 12
    s_lshl_b32 s81, s79, 15
    s_lshl_b32 s92, s73, 7
    s_add_u32 s81, s81, s92
    s_lshl_b32 s82, s72, 16
    s_add_u32 s82, s82, s80
    s_lshl_b32 s89, s79, 10
    s_add_u32 s92, s76, 1
    s_and_b32 s92, s92, 3
    s_lshl_b32 s83, s92, 14
    s_add_u32 s83, s83, s82
    s_lshl_b32 s86, s92, 12
    s_add_u32 s86, s86, s89
    s_add_u32 s92, s76, 2
    s_and_b32 s92, s92, 3
    s_lshl_b32 s84, s92, 14
    s_add_u32 s84, s84, s82
    s_lshl_b32 s87, s92, 12
    s_add_u32 s87, s87, s89
    s_add_u32 s92, s76, 3
    s_and_b32 s92, s92, 3
    s_lshl_b32 s85, s92, 14
    s_add_u32 s85, s85, s82
    s_lshl_b32 s88, s92, 12
    s_add_u32 s88, s88, s89
    v_mov_b32 v122, 160256
    v_mov_b32 v123, 1
    s_waitcnt lgkmcnt(0)
    s_mov_b32 s99, 5373952
    s_load_dword s99, s[64:65], s99
    s_barrier
    s_add_u32 s93, s72, 0
    s_and_b32 s93, s93, 3
    s_lshl_b32 s94, s93, 8
    s_lshl_b32 s93, s93, 17
    s_add_u32 s93, s93, s81
    s_add_u32 m0, s80, 16384
    s_add_u32 s92, s93, 0
    buffer_load_dwordx4 v12, s[36:39], s92 offen lds
    s_add_u32 m0, s80, 17408
    s_add_u32 s92, s93, 8192
    buffer_load_dwordx4 v12, s[36:39], s92 offen lds
    s_add_u32 m0, s80, 18432
    s_add_u32 s92, s93, 16384
    buffer_load_dwordx4 v12, s[36:39], s92 offen lds
    s_add_u32 m0, s80, 19456
    s_add_u32 s92, s93, 24576
    buffer_load_dwordx4 v12, s[36:39], s92 offen lds
    s_add_u32 m0, s86, 0
    s_add_u32 s92, s83, s94
    buffer_load_dwordx4 v8, s[32:35], s92 offen nt lds
    s_add_u32 m0, s87, 0
    s_add_u32 s92, s84, s94
    buffer_load_dwordx4 v8, s[32:35], s92 offen nt lds
    s_add_u32 m0, s88, 0
    s_add_u32 s92, s85, s94
    buffer_load_dwordx4 v8, s[32:35], s92 offen nt lds
    s_add_u32 s93, s72, 1
    s_and_b32 s93, s93, 3
    s_lshl_b32 s94, s93, 8
    s_lshl_b32 s93, s93, 17
    s_add_u32 s93, s93, s81
    s_add_u32 m0, s80, 49152
    s_add_u32 s92, s93, 0
    buffer_load_dwordx4 v12, s[36:39], s92 offen lds
    s_add_u32 m0, s80, 50176
    s_add_u32 s92, s93, 8192
    buffer_load_dwordx4 v12, s[36:39], s92 offen lds
    s_add_u32 m0, s80, 51200
    s_add_u32 s92, s93, 16384
    buffer_load_dwordx4 v12, s[36:39], s92 offen lds
    s_add_u32 m0, s80, 52224
    s_add_u32 s92, s93, 24576
    buffer_load_dwordx4 v12, s[36:39], s92 offen lds
    s_add_u32 m0, s86, 32768
    s_add_u32 s92, s83, s94
    buffer_load_dwordx4 v8, s[32:35], s92 offen nt lds
    s_add_u32 m0, s87, 32768
    s_add_u32 s92, s84, s94
    buffer_load_dwordx4 v8, s[32:35], s92 offen nt lds
    s_add_u32 m0, s88, 32768
    s_add_u32 s92, s85, s94
    buffer_load_dwordx4 v8, s[32:35], s92 offen nt lds
    v_and_b32 v104, 31, v0
    v_cmp_eq_u32 vcc, 16, v104
    v_mov_b32 v105, 0x4f804f80
    v_lshlrev_b32 v1, 4, v0
    v_cndmask_b32 v40, 0, v105, vcc
    v_mov_b32 v41, v40
    v_mov_b32 v42, v40
    v_mov_b32 v43, v40
    v_mov_b32 v44, v40
    v_mov_b32 v45, v40
    v_mov_b32 v46, v40
    v_mov_b32 v47, v40
    v_mov_b32 v48, v40
    v_mov_b32 v49, v40
    v_mov_b32 v50, v40
    v_mov_b32 v51, v40
    v_mov_b32 v52, v40
    v_mov_b32 v53, v40
    v_mov_b32 v54, v40
    v_mov_b32 v55, v40
    v_mov_b32 v56, v40
    v_mov_b32 v57, v40
    v_mov_b32 v58, v40
    v_mov_b32 v59, v40
    v_mov_b32 v60, v40
    v_mov_b32 v61, v40
    v_mov_b32 v62, v40
    v_mov_b32 v63, v40
    v_mov_b32 v64, v40
    v_mov_b32 v65, v40
    v_mov_b32 v66, v40
    v_mov_b32 v67, v40
    v_mov_b32 v68, v40
    v_mov_b32 v69, v40
    v_mov_b32 v70, v40
    v_mov_b32 v71, v40
    v_mov_b32 v72, v40
    v_mov_b32 v73, v40
    v_mov_b32 v74, v40
    v_mov_b32 v75, v40
    v_mov_b32 v76, v40
    v_mov_b32 v77, v40
    v_mov_b32 v78, v40
    v_mov_b32 v79, v40
    v_mov_b32 v80, v40
    v_mov_b32 v81, v40
    v_mov_b32 v82, v40
    v_mov_b32 v83, v40
    v_mov_b32 v84, v40
    v_mov_b32 v85, v40
    v_mov_b32 v86, v40
    v_mov_b32 v87, v40
    v_mov_b32 v88, v40
    v_mov_b32 v89, v40
    v_mov_b32 v90, v40
    v_mov_b32 v91, v40
    v_mov_b32 v92, v40
    v_mov_b32 v93, v40
    v_mov_b32 v94, v40
    v_mov_b32 v95, v40
    v_mov_b32 v96, v40
    v_mov_b32 v97, v40
    v_mov_b32 v98, v40
    v_mov_b32 v99, v40
    v_mov_b32 v100, v40
    v_mov_b32 v101, v40
    v_mov_b32 v102, v40
    v_mov_b32 v103, v40
    v_lshlrev_b32 v2, 4, v104
    v_add_u32 v2, 155648, v2
    v_lshrrev_b32 v120, 5, v0
    v_lshlrev_b32 v120, 8, v120
    v_and_b32 v106, 15, v0
    v_lshl_add_u32 v120, v106, 4, v120
    s_waitcnt lgkmcnt(0)
    s_add_u32 s99, s99, 1
    s_mul_i32 s71, s99, 0x9e3779b1
    s_waitcnt vmcnt(7)
    s_mov_b64 exec, 1
    ds_add_u32 v122, v123 offset:32
    s_mov_b64 exec, -1
L_poll_2:
    ds_read_b32 v104, v122 offset:12
    s_waitcnt lgkmcnt(0)
    v_readfirstlane_b32 s98, v104
    s_cmp_ge_u32 s98, 1
    s_cbranch_scc1 L_poll_2_d
    s_sleep 1
    s_add_u32 s100, s100, 1
    s_cmp_lt_u32 s100, 60000
    s_cbranch_scc1 L_poll_2
L_poll_2_d:
    s_add_u32 s93, s72, 2
    s_and_b32 s93, s93, 3
    s_lshl_b32 s94, s93, 8
    s_lshl_b32 s93, s93, 17
    s_add_u32 s93, s93, s81
    s_add_u32 m0, s80, 81920
    s_add_u32 s92, s93, 0
    buffer_load_dwordx4 v12, s[36:39], s92 offen lds
    s_add_u32 m0, s80, 82944
    s_add_u32 s92, s93, 8192
    buffer_load_dwordx4 v12, s[36:39], s92 offen lds
    s_add_u32 m0, s80, 83968
    s_add_u32 s92, s93, 16384
    buffer_load_dwordx4 v12, s[36:39], s92 offen lds
    s_add_u32 m0, s80, 84992
    s_add_u32 s92, s93, 24576
    buffer_load_dwordx4 v12, s[36:39], s92 offen lds
    s_add_u32 m0, s86, 65536
    s_add_u32 s92, s83, s94
    buffer_load_dwordx4 v8, s[32:35], s92 offen nt lds
    s_add_u32 m0, s87, 65536
    s_add_u32 s92, s84, s94
    buffer_load_dwordx4 v8, s[32:35], s92 offen nt lds
    s_add_u32 m0, s88, 65536
    s_add_u32 s92, s85, s94
    buffer_load_dwordx4 v8, s[32:35], s92 offen nt lds
    s_waitcnt vmcnt(7)
    s_mov_b64 exec, 1
    ds_add_u32 v122, v123 offset:36
    s_mov_b64 exec, -1
    s_add_u32 s93, s72, 3
    s_and_b32 s93, s93, 3
    s_lshl_b32 s94, s93, 8
    s_lshl_b32 s93, s93, 17
    s_add_u32 s93, s93, s81
    s_add_u32 m0, s80, 114688
    s_add_u32 s92, s93, 0
    buffer_load_dwordx4 v12, s[36:39], s92 offen lds
    s_add_u32 m0, s80, 115712
    s_add_u32 s92, s93, 8192
    buffer_load_dwordx4 v12, s[36:39], s92 offen lds
    s_add_u32 m0, s80, 116736
    s_add_u32 s92, s93, 16384
    buffer_load_dwordx4 v12, s[36:39], s92 offen lds
    s_add_u32 m0, s80, 117760
    s_add_u32 s92, s93, 24576
    buffer_load_dwordx4 v12, s[36:39], s92 offen lds
    s_add_u32 m0, s86, 98304
    s_add_u32 s92, s83, s94
    buffer_load_dwordx4 v8, s[32:35], s92 offen nt lds
    s_add_u32 m0, s87, 98304
    s_add_u32 s92, s84, s94
    buffer_load_dwordx4 v8, s[32:35], s92 offen nt lds
    s_add_u32 m0, s88, 98304
    s_add_u32 s92, s85, s94
    buffer_load_dwordx4 v8, s[32:35], s92 offen nt lds
    s_waitcnt vmcnt(7)
    s_mov_b64 exec, 1
    ds_add_u32 v122, v123 offset:40
    s_mov_b64 exec, -1
    s_waitcnt vmcnt(0)
    s_mov_b64 exec, 1
    ds_add_u32 v122, v123 offset:44
    s_mov_b64 exec, -1
    s_branch L_f2
L_q:
    s_lshl_b32 s92, s3, 8
    s_add_u32 m0, s92, 159744
    v_mov_b32 v2, 0
    ds_write_addtid_b32 v2
    s_mov_b32 m0, 160256
    s_nop 0
    ds_write_addtid_b32 v2
    s_waitcnt lgkmcnt(0)
    s_mov_b32 s99, 5373952
    s_load_dword s99, s[64:65], s99
    s_barrier
    v_mov_b32 v122, 160256
    v_mov_b32 v123, 1
    v_and_b32 v104, 31, v0
    v_cmp_eq_u32 vcc, 16, v104
    v_mov_b32 v105, 0x4f804f80
    v_lshlrev_b32 v1, 4, v0
    v_cndmask_b32 v40, 0, v105, vcc
    v_mov_b32 v41, v40
    v_mov_b32 v42, v40
    v_mov_b32 v43, v40
    v_mov_b32 v44, v40
    v_mov_b32 v45, v40
    v_mov_b32 v46, v40
    v_mov_b32 v47, v40
    v_mov_b32 v48, v40
    v_mov_b32 v49, v40
    v_mov_b32 v50, v40
    v_mov_b32 v51, v40
    v_mov_b32 v52, v40
    v_mov_b32 v53, v40
    v_mov_b32 v54, v40
    v_mov_b32 v55, v40
    v_mov_b32 v56, v40
    v_mov_b32 v57, v40
    v_mov_b32 v58, v40
    v_mov_b32 v59, v40
    v_mov_b32 v60, v40
    v_mov_b32 v61, v40
    v_mov_b32 v62, v40
    v_mov_b32 v63, v40
    v_mov_b32 v64, v40
    v_mov_b32 v65, v40
    v_mov_b32 v66, v40
    v_mov_b32 v67, v40
    v_mov_b32 v68, v40
    v_mov_b32 v69, v40
    v_mov_b32 v70, v40
    v_mov_b32 v71, v40
    v_mov_b32 v72, v40
    v_mov_b32 v73, v40
    v_mov_b32 v74, v40
    v_mov_b32 v75, v40
    v_mov_b32 v76, v40
    v_mov_b32 v77, v40
    v_mov_b32 v78, v40
    v_mov_b32 v79, v40
    v_mov_b32 v80, v40
    v_mov_b32 v81, v40
    v_mov_b32 v82, v40
    v_mov_b32 v83, v40
    v_mov_b32 v84, v40
    v_mov_b32 v85, v40
    v_mov_b32 v86, v40
    v_mov_b32 v87, v40
    v_mov_b32 v88, v40
    v_mov_b32 v89, v40
    v_mov_b32 v90, v40
    v_mov_b32 v91, v40
    v_mov_b32 v92, v40
    v_mov_b32 v93, v40
    v_mov_b32 v94, v40
    v_mov_b32 v95, v40
    v_mov_b32 v96, v40
    v_mov_b32 v97, v40
    v_mov_b32 v98, v40
    v_mov_b32 v99, v40
    v_mov_b32 v100, v40
    v_mov_b32 v101, v40
    v_mov_b32 v102, v40
    v_mov_b32 v103, v40
    v_lshlrev_b32 v2, 4, v104
    v_add_u32 v2, 155648, v2
    v_lshrrev_b32 v120, 5, v0
    v_lshlrev_b32 v120, 8, v120
    v_and_b32 v106, 15, v0
    v_lshl_add_u32 v120, v106, 4, v120
    s_and_b32 s92, s79, 1
    s_lshl_b32 s92, s92, 13
    v_and_b32 v28, 31, v0
    v_lshrrev_b32 v29, 5, v0
    v_and_b32 v30, 15, v0
    v_xor_b32 v30, v30, v29
    v_lshl_add_u32 v31, v28, 8, s92
    v_lshl_add_u32 v8, v30, 4, v31
    v_xor_b32 v9, 32, v8
    v_xor_b32 v10, 64, v8
    v_xor_b32 v11, 96, v8
    v_xor_b32 v12, 128, v8
    v_xor_b32 v13, 160, v8
    v_xor_b32 v14, 192, v8
    v_xor_b32 v15, 224, v8
    v_bfe_u32 v28, v0, 2, 2
    v_lshl_add_u32 v30, v29, 3, v28
    v_lshlrev_b32 v30, 7, v30
    v_lshrrev_b32 v28, 1, v28
    s_lshr_b32 s92, s79, 1
    v_xor_b32 v28, s92, v28
    v_lshl_add_u32 v30, v28, 6, v30
    v_bfe_u32 v28, v0, 4, 1
    v_lshl_add_u32 v30, v28, 5, v30
    v_and_b32 v28, 3, v0
    v_lshl_add_u32 v30, v28, 3, v30
    v_add_u32 v16, 16384, v30
    v_lshl_add_u32 v27, v28, 2, v122
    v_add_u32 v17, 65536, v8
    v_add_u32 v18, 65536, v9
    v_add_u32 v19, 65536, v10
    v_add_u32 v20, 65536, v11
    v_add_u32 v21, 65536, v12
    v_add_u32 v22, 65536, v13
    v_add_u32 v23, 65536, v14
    v_add_u32 v24, 65536, v15
    v_add_u32 v25, 65536, v16
    s_waitcnt lgkmcnt(0)
    s_add_u32 s99, s99, 1
    s_mul_i32 s71, s99, 0x9e3779b1
    s_mov_b32 s86, 0x3eb8aa3b
    s_and_b32 s92, s79, 2
    s_add_u32 s92, s92, s79
    s_mov_b32 s93, s92
    s_lshl_b32 s92, s92, 10
    s_add_u32 s92, s92, 147456
    v_add_u32 v29, s92, v1
    s_lshl_b32 s93, s93, 10
    s_add_u32 s93, s93, 147456
    v_add_u32 v26, s93, v1
    s_lshl_b32 s92, s79, 2
    v_add_u32 v121, s92, v122
    s_sub_u32 s88, s3, 4
    s_lshl_b32 s94, s88, 13
    s_add_u32 s92, s94, 5242880
    s_add_u32 s93, s94, 5308416
    s_add_u32 s94, s92, 4096
    s_add_u32 s95, s93, 4096
    s_setprio 3
L_ql_3:
    ds_read_b32 v28, v27 offset:32
    s_waitcnt lgkmcnt(0)
    v_cmp_gt_u32 vcc, 5, v28
    s_and_b32 s97, vcc_lo, 15
    s_and_b32 s96, s97, 1
    s_cbranch_scc0 L_ql_3_d
    s_sleep 1
    s_add_u32 s100, s100, 1
    s_cmp_lt_u32 s100, 60000
    s_cbranch_scc1 L_ql_3
L_ql_3_d:
    ds_read_b128 v[124:127], v8 offset:0
    ds_read_b64_tr_b16 v[128:129], v16 offset:0
    ds_read_b64_tr_b16 v[130:131], v16 offset:512
    ds_read_b128 v[132:135], v9 offset:0
    ds_read_b64_tr_b16 v[136:137], v16 offset:2048
    ds_read_b64_tr_b16 v[138:139], v16 offset:2560
    ds_read_b128 v[140:143], v10 offset:0
    ds_read_b64_tr_b16 v[144:145], v16 offset:4096
    ds_read_b64_tr_b16 v[146:147], v16 offset:4608
    ds_read_b128 v[148:151], v11 offset:0
    ds_read_b64_tr_b16 v[152:153], v16 offset:6144
    ds_read_b64_tr_b16 v[154:155], v16 offset:6656
    ds_read_b128 v[156:159], v12 offset:0
    ds_read_b64_tr_b16 v[160:161], v16 offset:8192
    ds_read_b64_tr_b16 v[162:163], v16 offset:8704
    s_waitcnt lgkmcnt(12)
    v_mfma_f32_32x32x16_bf16 v[104:119], v[128:131], v[124:127], 0
    ds_read_b128 v[124:127], v13 offset:0
    ds_read_b64_tr_b16 v[128:129], v16 offset:10240
    ds_read_b64_tr_b16 v[130:131], v16 offset:10752
    s_waitcnt lgkmcnt(12)
    v_mfma_f32_32x32x16_bf16 v[104:119], v[136:139], v[132:135], v[104:119]
    ds_read_b128 v[132:135], v14 offset:0
    ds_read_b64_tr_b16 v[136:137], v16 offset:12288
    ds_read_b64_tr_b16 v[138:139], v16 offset:12800
    s_waitcnt lgkmcnt(12)
    v_mfma_f32_32x32x16_bf16 v[104:119], v[144:147], v[140:143], v[104:119]
    ds_read_b128 v[140:143], v15 offset:0
    ds_read_b64_tr_b16 v[144:145], v16 offset:14336
    ds_read_b64_tr_b16 v[146:147], v16 offset:14848
    s_waitcnt lgkmcnt(12)
    v_mfma_f32_32x32x16_bf16 v[104:119], v[152:155], v[148:151], v[104:119]
    s_and_b32 s96, s97, 2
    s_cbranch_scc0 L_lok_4
L_ql_5:
    ds_read_b32 v28, v27 offset:32
    s_waitcnt lgkmcnt(0)
    v_cmp_gt_u32 vcc, 5, v28
    s_and_b32 s97, vcc_lo, 15
    s_and_b32 s96, s97, 2
    s_cbranch_scc0 L_ql_5_d
    s_sleep 1
    s_add_u32 s100, s100, 1
    s_cmp_lt_u32 s100, 60000
    s_cbranch_scc1 L_ql_5
L_ql_5_d:
L_lok_4:
    ds_read_b128 v[148:151], v8 offset:32768
    ds_read_b64_tr_b16 v[152:153], v16 offset:32768
    ds_read_b64_tr_b16 v[154:155], v16 offset:33280
    s_waitcnt lgkmcnt(12)
    v_mfma_f32_32x32x16_bf16 v[104:119], v[160:163], v[156:159], v[104:119]
    ds_read_b128 v[156:159], v9 offset:32768
    ds_read_b64_tr_b16 v[160:161], v16 offset:34816
    ds_read_b64_tr_b16 v[162:163], v16 offset:35328
    s_waitcnt lgkmcnt(12)
    v_mfma_f32_32x32x16_bf16 v[104:119], v[128:131], v[124:127], v[104:119]
    ds_read_b128 v[124:127], v10 offset:32768
    ds_read_b64_tr_b16 v[128:129], v16 offset:36864
    ds_read_b64_tr_b16 v[130:131], v16 offset:37376
    s_waitcnt lgkmcnt(12)
    v_mfma_f32_32x32x16_bf16 v[104:119], v[136:139], v[132:135], v[104:119]
    ds_read_b128 v[132:135], v11 offset:32768
    ds_read_b64_tr_b16 v[136:137], v16 offset:38912
    ds_read_b64_tr_b16 v[138:139], v16 offset:39424
    s_waitcnt lgkmcnt(12)
    v_mfma_f32_32x32x16_bf16 v[104:119], v[144:147], v[140:143], v[104:119]
    ds_read_b128 v[140:143], v12 offset:32768
    ds_read_b64_tr_b16 v[144:145], v16 offset:40960
    ds_read_b64_tr_b16 v[146:147], v16 offset:41472
    s_waitcnt lgkmcnt(12)
    v_mfma_f32_32x32x16_bf16 v[104:119], v[152:155], v[148:151], v[104:119]
    ds_read_b128 v[148:151], v13 offset:32768
    ds_read_b64_tr_b16 v[152:153], v16 offset:43008
    ds_read_b64_tr_b16 v[154:155], v16 offset:43520
    s_waitcnt lgkmcnt(12)
    v_mfma_f32_32x32x16_bf16 v[104:119], v[160:163], v[156:159], v[104:119]
    ds_read_b128 v[156:159], v14 offset:32768
    ds_read_b64_tr_b16 v[160:161], v16 offset:45056
    ds_read_b64_tr_b16 v[162:163], v16 offset:45568
    s_waitcnt lgkmcnt(12)
    v_mfma_f32_32x32x16_bf16 v[104:119], v[128:131], v[124:127], v[104:119]
    ds_read_b128 v[124:127], v15 offset:32768
    ds_read_b64_tr_b16 v[128:129], v16 offset:47104
    ds_read_b64_tr_b16 v[130:131], v16 offset:47616
    s_waitcnt lgkmcnt(12)
    v_mfma_f32_32x32x16_bf16 v[104:119], v[136:139], v[132:135], v[104:119]
    s_and_b32 s96, s97, 4
    s_cbranch_scc0 L_lok_6
L_ql_7:
    ds_read_b32 v28, v27 offset:32
    s_waitcnt lgkmcnt(0)
    v_cmp_gt_u32 vcc, 5, v28
    s_and_b32 s97, vcc_lo, 15
    s_and_b32 s96, s97, 4
    s_cbranch_scc0 L_ql_7_d
    s_sleep 1
    s_add_u32 s100, s100, 1
    s_cmp_lt_u32 s100, 60000
    s_cbranch_scc1 L_ql_7
L_ql_7_d:
L_lok_6:
    ds_read_b128 v[132:135], v17 offset:0
    ds_read_b64_tr_b16 v[136:137], v25 offset:0
    ds_read_b64_tr_b16 v[138:139], v25 offset:512
    s_waitcnt lgkmcnt(12)
    v_mfma_f32_32x32x16_bf16 v[104:119], v[144:147], v[140:143], v[104:119]
    ds_read_b128 v[140:143], v18 offset:0
    ds_read_b64_tr_b16 v[144:145], v25 offset:2048
    ds_read_b64_tr_b16 v[146:147], v25 offset:2560
    s_waitcnt lgkmcnt(12)
    v_mfma_f32_32x32x16_bf16 v[104:119], v[152:155], v[148:151], v[104:119]
    ds_read_b128 v[148:151], v19 offset:0
    ds_read_b64_tr_b16 v[152:153], v25 offset:4096
    ds_read_b64_tr_b16 v[154:155], v25 offset:4608
    s_waitcnt lgkmcnt(12)
    v_mfma_f32_32x32x16_bf16 v[104:119], v[160:163], v[156:159], v[104:119]
    ds_read_b128 v[156:159], v20 offset:0
    ds_read_b64_tr_b16 v[160:161], v25 offset:6144
    ds_read_b64_tr_b16 v[162:163], v25 offset:6656
    s_waitcnt lgkmcnt(12)
    v_mfma_f32_32x32x16_bf16 v[104:119], v[128:131], v[124:127], v[104:119]
    ds_read_b128 v[124:127], v21 offset:0
    ds_read_b64_tr_b16 v[128:129], v25 offset:8192
    ds_read_b64_tr_b16 v[130:131], v25 offset:8704
    s_waitcnt lgkmcnt(12)
    v_mfma_f32_32x32x16_bf16 v[104:119], v[136:139], v[132:135], v[104:119]
    ds_read_b128 v[132:135], v22 offset:0
    ds_read_b64_tr_b16 v[136:137], v25 offset:10240
    ds_read_b64_tr_b16 v[138:139], v25 offset:10752
    s_waitcnt lgkmcnt(12)
    v_mfma_f32_32x32x16_bf16 v[104:119], v[144:147], v[140:143], v[104:119]
    ds_read_b128 v[140:143], v23 offset:0
    ds_read_b64_tr_b16 v[144:145], v25 offset:12288
    ds_read_b64_tr_b16 v[146:147], v25 offset:12800
    s_waitcnt lgkmcnt(12)
    v_mfma_f32_32x32x16_bf16 v[104:119], v[152:155], v[148:151], v[104:119]
    ds_read_b128 v[148:151], v24 offset:0
    ds_read_b64_tr_b16 v[152:153], v25 offset:14336
    ds_read_b64_tr_b16 v[154:155], v25 offset:14848
    s_waitcnt lgkmcnt(12)
    v_mfma_f32_32x32x16_bf16 v[104:119], v[160:163], v[156:159], v[104:119]
    s_and_b32 s96, s97, 8
    s_cbranch_scc0 L_lok_8
L_ql_9:
    ds_read_b32 v28, v27 offset:32
    s_waitcnt lgkmcnt(0)
    v_cmp_gt_u32 vcc, 5, v28
    s_and_b32 s97, vcc_lo, 15
    s_and_b32 s96, s97, 8
    s_cbranch_scc0 L_ql_9_d
    s_sleep 1
    s_add_u32 s100, s100, 1
    s_cmp_lt_u32 s100, 60000
    s_cbranch_scc1 L_ql_9
L_ql_9_d:
L_lok_8:
    ds_read_b128 v[156:159], v17 offset:32768
    ds_read_b64_tr_b16 v[160:161], v25 offset:32768
    ds_read_b64_tr_b16 v[162:163], v25 offset:33280
    s_waitcnt lgkmcnt(12)
    v_mfma_f32_32x32x16_bf16 v[104:119], v[128:131], v[124:127], v[104:119]
    ds_read_b128 v[124:127], v18 offset:32768
    ds_read_b64_tr_b16 v[128:129], v25 offset:34816
    ds_read_b64_tr_b16 v[130:131], v25 offset:35328
    s_waitcnt lgkmcnt(12)
    v_mfma_f32_32x32x16_bf16 v[104:119], v[136:139], v[132:135], v[104:119]
    ds_read_b128 v[132:135], v19 offset:32768
    ds_read_b64_tr_b16 v[136:137], v25 offset:36864
    ds_read_b64_tr_b16 v[138:139], v25 offset:37376
    s_waitcnt lgkmcnt(12)
    v_mfma_f32_32x32x16_bf16 v[104:119], v[144:147], v[140:143], v[104:119]
    ds_read_b128 v[140:143], v20 offset:32768
    ds_read_b64_tr_b16 v[144:145], v25 offset:38912
    ds_read_b64_tr_b16 v[146:147], v25 offset:39424
    s_waitcnt lgkmcnt(12)
    v_mfma_f32_32x32x16_bf16 v[104:119], v[152:155], v[148:151], v[104:119]
    ds_read_b128 v[148:151], v21 offset:32768
    ds_read_b64_tr_b16 v[152:153], v25 offset:40960
    ds_read_b64_tr_b16 v[154:155], v25 offset:41472
    s_waitcnt lgkmcnt(12)
    v_mfma_f32_32x32x16_bf16 v[104:119], v[160:163], v[156:159], v[104:119]
    ds_read_b128 v[156:159], v22 offset:32768
    ds_read_b64_tr_b16 v[160:161], v25 offset:43008
    ds_read_b64_tr_b16 v[162:163], v25 offset:43520
    s_waitcnt lgkmcnt(12)
    v_mfma_f32_32x32x16_bf16 v[104:119], v[128:131], v[124:127], v[104:119]
    ds_read_b128 v[124:127], v23 offset:32768
    ds_read_b64_tr_b16 v[128:129], v25 offset:45056
    ds_read_b64_tr_b16 v[130:131], v25 offset:45568
    s_waitcnt lgkmcnt(12)
    v_mfma_f32_32x32x16_bf16 v[104:119], v[136:139], v[132:135], v[104:119]
    ds_read_b128 v[132:135], v24 offset:32768
    ds_read_b64_tr_b16 v[136:137], v25 offset:47104
    ds_read_b64_tr_b16 v[138:139], v25 offset:47616
    s_waitcnt lgkmcnt(12)
    v_mfma_f32_32x32x16_bf16 v[104:119], v[144:147], v[140:143], v[104:119]
    s_waitcnt lgkmcnt(9)
    v_mfma_f32_32x32x16_bf16 v[104:119], v[152:155], v[148:151], v[104:119]
    s_waitcnt lgkmcnt(6)
    v_mfma_f32_32x32x16_bf16 v[104:119], v[160:163], v[156:159], v[104:119]
    s_waitcnt lgkmcnt(3)
    v_mfma_f32_32x32x16_bf16 v[104:119], v[128:131], v[124:127], v[104:119]
    s_waitcnt lgkmcnt(0)
    v_mfma_f32_32x32x16_bf16 v[104:119], v[136:139], v[132:135], v[104:119]
    v_mov_b32 v30, s86
    s_nop 0
    s_nop 0
    s_nop 0
    s_nop 0
    s_nop 0
    s_nop 0
    s_nop 0
    s_nop 0
    s_nop 0
    s_nop 0
    s_nop 0
    v_pk_mul_f32 v[104:105], v[104:105], v[30:31] op_sel_hi:[1,0]
    v_pk_mul_f32 v[106:107], v[106:107], v[30:31] op_sel_hi:[1,0]
    v_pk_mul_f32 v[108:109], v[108:109], v[30:31] op_sel_hi:[1,0]
    v_pk_mul_f32 v[110:111], v[110:111], v[30:31] op_sel_hi:[1,0]
    v_pk_mul_f32 v[112:113], v[112:113], v[30:31] op_sel_hi:[1,0]
    v_pk_mul_f32 v[114:115], v[114:115], v[30:31] op_sel_hi:[1,0]
    v_pk_mul_f32 v[116:117], v[116:117], v[30:31] op_sel_hi:[1,0]
    v_pk_mul_f32 v[118:119], v[118:119], v[30:31] op_sel_hi:[1,0]
    v_cvt_pk_bf16_f32 v136, v104, v105
    v_cvt_pk_bf16_f32 v137, v106, v107
    v_cvt_pk_bf16_f32 v138, v108, v109
    v_cvt_pk_bf16_f32 v139, v110, v111
    v_cvt_pk_bf16_f32 v140, v112, v113
    v_cvt_pk_bf16_f32 v141, v114, v115
    v_cvt_pk_bf16_f32 v142, v116, v117
    v_cvt_pk_bf16_f32 v143, v118, v119
    ds_write_b128 v29, v[136:139]
    ds_write_b128 v26, v[140:143] offset:2048
    s_mov_b64 exec, 1
    ds_add_u32 v122, v123 offset:4
    s_mov_b64 exec, -1
L_poll_10:
    ds_read_b32 v106, v121 offset:48
    s_waitcnt lgkmcnt(0)
    v_readfirstlane_b32 s98, v106
    s_cmp_ge_u32 s98, 1
    s_cbranch_scc1 L_poll_10_d
    s_sleep 1
    s_add_u32 s100, s100, 1
    s_cmp_lt_u32 s100, 60000
    s_cbranch_scc1 L_poll_10
L_poll_10_d:
L_poll_11:
    ds_read_b32 v106, v122 offset:8
    s_waitcnt lgkmcnt(0)
    v_readfirstlane_b32 s98, v106
    s_cmp_ge_u32 s98, 4
    s_cbranch_scc1 L_poll_11_d
    s_sleep 2
    s_add_u32 s100, s100, 1
    s_cmp_lt_u32 s100, 60000
    s_cbranch_scc1 L_poll_11
L_poll_11_d:
    buffer_load_dwordx4 v[8:11], v1, s[64:67], s92 offen offset:0 sc1
    s_mov_b32 exec_lo, 0xffff
    s_mov_b32 exec_hi, 0xffff
    buffer_load_dwordx4 v[40:43], v120, s[64:67], s93 offen offset:0 sc1
    buffer_load_dwordx4 v[44:47], v120, s[64:67], s93 offen offset:512 sc1
    s_mov_b64 exec, -1
    buffer_load_dwordx4 v[12:15], v1, s[64:67], s92 offen offset:1024 sc1
    s_mov_b32 exec_lo, 0xffff
    s_mov_b32 exec_hi, 0xffff
    buffer_load_dwordx4 v[48:51], v120, s[64:67], s93 offen offset:1024 sc1
    buffer_load_dwordx4 v[52:55], v120, s[64:67], s93 offen offset:1536 sc1
    s_mov_b64 exec, -1
    buffer_load_dwordx4 v[16:19], v1, s[64:67], s92 offen offset:2048 sc1
    s_mov_b32 exec_lo, 0xffff
    s_mov_b32 exec_hi, 0xffff
    buffer_load_dwordx4 v[56:59], v120, s[64:67], s93 offen offset:2048 sc1
    buffer_load_dwordx4 v[60:63], v120, s[64:67], s93 offen offset:2560 sc1
    s_mov_b64 exec, -1
    buffer_load_dwordx4 v[20:23], v1, s[64:67], s92 offen offset:3072 sc1
    s_mov_b32 exec_lo, 0xffff
    s_mov_b32 exec_hi, 0xffff
    buffer_load_dwordx4 v[64:67], v120, s[64:67], s93 offen offset:3072 sc1
    buffer_load_dwordx4 v[68:71], v120, s[64:67], s93 offen offset:3584 sc1
    s_mov_b64 exec, -1
    buffer_load_dwordx4 v[24:27], v1, s[64:67], s94 offen offset:0 sc1
    s_mov_b32 exec_lo, 0xffff
    s_mov_b32 exec_hi, 0xffff
    buffer_load_dwordx4 v[72:75], v120, s[64:67], s95 offen offset:0 sc1
    buffer_load_dwordx4 v[76:79], v120, s[64:67], s95 offen offset:512 sc1
    s_mov_b64 exec, -1
    buffer_load_dwordx4 v[28:31], v1, s[64:67], s94 offen offset:1024 sc1
    s_mov_b32 exec_lo, 0xffff
    s_mov_b32 exec_hi, 0xffff
    buffer_load_dwordx4 v[80:83], v120, s[64:67], s95 offen offset:1024 sc1
    buffer_load_dwordx4 v[84:87], v120, s[64:67], s95 offen offset:1536 sc1
    s_mov_b64 exec, -1
    buffer_load_dwordx4 v[32:35], v1, s[64:67], s94 offen offset:2048 sc1
    s_mov_b32 exec_lo, 0xffff
    s_mov_b32 exec_hi, 0xffff
    buffer_load_dwordx4 v[88:91], v120, s[64:67], s95 offen offset:2048 sc1
    buffer_load_dwordx4 v[92:95], v120, s[64:67], s95 offen offset:2560 sc1
    s_mov_b64 exec, -1
    buffer_load_dwordx4 v[36:39], v1, s[64:67], s94 offen offset:3072 sc1
    s_mov_b32 exec_lo, 0xffff
    s_mov_b32 exec_hi, 0xffff
    buffer_load_dwordx4 v[96:99], v120, s[64:67], s95 offen offset:3072 sc1
    buffer_load_dwordx4 v[100:103], v120, s[64:67], s95 offen offset:3584 sc1
    s_mov_b64 exec, -1
    s_mov_b64 exec, 1
    ds_add_u32 v122, v123 offset:8
    s_mov_b64 exec, -1
    s_mul_i32 s90, s79, 2304
    s_add_u32 s90, s90, 73728
    v_add_u32 v3, s90, v1
    v_lshl_add_u32 v0, v0, 2, s90
    v_add_u32 v1, 147456, v1
    s_lshl_b32 s96, s79, 8
    s_add_u32 m0, s96, 160768
    s_mov_b32 s89, 0
    v_mov_b32 v104, m0
    s_setprio 0
L_poll_12:
    ds_read_b32 v105, v104 offset:0
    s_waitcnt lgkmcnt(0)
    v_readfirstlane_b32 s98, v105
    s_cmp_ge_u32 s98, 1
    s_cbranch_scc1 L_poll_12_d
    s_sleep 6
    s_add_u32 s100, s100, 1
    s_cmp_lt_u32 s100, 60000
    s_cbranch_scc1 L_poll_12
L_poll_12_d:
    ds_read_b128 v[4:7], v1
    ds_read_b128 v[152:155], v2
    ds_read_b128 v[156:159], v2
    ds_read_b128 v[160:163], v2
    ds_read_b128 v[164:167], v2
    s_waitcnt vmcnt(0) lgkmcnt(0)
    v_mfma_f32_32x32x16_bf16 v[104:119], v[8:11], v[4:7], v[152:167]
    s_nop 0
    s_nop 0
    s_nop 0
    s_nop 0
    s_nop 0
    s_nop 0
    s_nop 0
    s_nop 0
    s_nop 0
    s_nop 0
    s_nop 0
    s_nop 0
    .p2align 3
L_bloop:
    v_mfma_f32_32x32x16_bf16 v[136:151], v[96:99], v[120:123], v[136:151]
    v_exp_f32 v104, v104
    v_cvt_pk_bf16_f32 v131, v134, v135
    v_exp_f32 v105, v105
    v_exp_f32 v106, v106
    v_mfma_f32_32x32x16_bf16 v[136:151], v[100:103], v[128:131], v[136:151]
    v_exp_f32 v107, v107
    v_cvt_pk_bf16_f32 v104, v104, v105
    v_exp_f32 v108, v108
    v_cvt_pk_bf16_f32 v105, v106, v107
    v_mfma_f32_32x32x16_bf16 v[120:135], v[12:15], v[4:7], v[152:167]
    v_exp_f32 v109, v109
    v_exp_f32 v110, v110
    v_cvt_pk_bf16_f32 v106, v108, v109
    v_exp_f32 v111, v111
    v_exp_f32 v112, v112
    v_cvt_pk_bf16_f32 v107, v110, v111
    s_cmp_eq_u32 s89, 0
    s_cbranch_scc1 L_nodump_13
    ds_write_b128 v3, v[136:139]
    ds_write_b128 v3, v[140:143] offset:1024
    ds_write_b32 v0, v144 offset:2048
    ds_write_addtid_b32 v3 offset:1024
    v_add_u32 v3, 9216, v3
    v_add_u32 v0, 9216, v0
    s_add_u32 s90, s90, 9216
L_nodump_13:
    s_cmp_ge_u32 s98, s90
    s_cbranch_scc0 L_swait
L_swait_ret:
    ds_read_b128 v[136:139], v3 offset:0
    ds_read_b128 v[140:143], v3 offset:1024
    ds_read_b32 v144, v0 offset:2048
    v_exp_f32 v113, v113
    v_exp_f32 v114, v114
    v_cvt_pk_bf16_f32 v112, v112, v113
    v_exp_f32 v115, v115
    v_exp_f32 v116, v116
    v_cvt_pk_bf16_f32 v113, v114, v115
    v_exp_f32 v117, v117
    v_exp_f32 v118, v118
    v_cvt_pk_bf16_f32 v114, v116, v117
    v_exp_f32 v119, v119
    v_exp_f32 v120, v120
    v_cvt_pk_bf16_f32 v115, v118, v119
    v_exp_f32 v121, v121
    v_exp_f32 v122, v122
    s_waitcnt lgkmcnt(0)
    v_mfma_f32_32x32x16_bf16 v[136:151], v[40:43], v[104:107], v[136:151]
    v_exp_f32 v123, v123
    v_cvt_pk_bf16_f32 v120, v120, v121
    v_exp_f32 v124, v124
    v_cvt_pk_bf16_f32 v121, v122, v123
    v_mfma_f32_32x32x16_bf16 v[136:151], v[44:47], v[112:115], v[136:151]
    v_exp_f32 v125, v125
    v_exp_f32 v126, v126
    v_cvt_pk_bf16_f32 v122, v124, v125
    v_exp_f32 v127, v127
    v_mfma_f32_32x32x16_bf16 v[104:119], v[16:19], v[4:7], v[152:167]
    v_exp_f32 v128, v128
    v_cvt_pk_bf16_f32 v123, v126, v127
    v_exp_f32 v129, v129
    v_exp_f32 v130, v130
    v_cvt_pk_bf16_f32 v128, v128, v129
    v_exp_f32 v131, v131
    v_exp_f32 v132, v132
    s_wakeup
    v_cvt_pk_bf16_f32 v129, v130, v131
    v_exp_f32 v133, v133
    v_exp_f32 v134, v134
    v_cvt_pk_bf16_f32 v130, v132, v133
    v_exp_f32 v135, v135
    v_mfma_f32_32x32x16_bf16 v[136:151], v[48:51], v[120:123], v[136:151]
    v_exp_f32 v104, v104
    v_cvt_pk_bf16_f32 v131, v134, v135
    v_exp_f32 v105, v105
    v_exp_f32 v106, v106
    v_mfma_f32_32x32x16_bf16 v[136:151], v[52:55], v[128:131], v[136:151]
    v_exp_f32 v107, v107
    v_cvt_pk_bf16_f32 v104, v104, v105
    v_exp_f32 v108, v108
    v_cvt_pk_bf16_f32 v105, v106, v107
    v_mfma_f32_32x32x16_bf16 v[120:135], v[20:23], v[4:7], v[152:167]
    v_exp_f32 v109, v109
    v_exp_f32 v110, v110
    v_cvt_pk_bf16_f32 v106, v108, v109
    v_exp_f32 v111, v111
    v_exp_f32 v112, v112
    v_cvt_pk_bf16_f32 v107, v110, v111
    v_exp_f32 v113, v113
    v_exp_f32 v114, v114
    v_cvt_pk_bf16_f32 v112, v112, v113
    v_exp_f32 v115, v115
    v_exp_f32 v116, v116
    v_cvt_pk_bf16_f32 v113, v114, v115
    v_exp_f32 v117, v117
    v_exp_f32 v118, v118
    v_cvt_pk_bf16_f32 v114, v116, v117
    v_exp_f32 v119, v119
    v_mfma_f32_32x32x16_bf16 v[136:151], v[56:59], v[104:107], v[136:151]
    v_exp_f32 v120, v120
    v_cvt_pk_bf16_f32 v115, v118, v119
    v_exp_f32 v121, v121
    v_exp_f32 v122, v122
    v_mfma_f32_32x32x16_bf16 v[136:151], v[60:63], v[112:115], v[136:151]
    v_exp_f32 v123, v123
    v_cvt_pk_bf16_f32 v120, v120, v121
    v_exp_f32 v124, v124
    v_cvt_pk_bf16_f32 v121, v122, v123
    v_mfma_f32_32x32x16_bf16 v[104:119], v[24:27], v[4:7], v[152:167]
    v_exp_f32 v125, v125
    v_exp_f32 v126, v126
    v_cvt_pk_bf16_f32 v122, v124, v125
    v_exp_f32 v127, v127
    v_exp_f32 v128, v128
    v_cvt_pk_bf16_f32 v123, v126, v127
    v_exp_f32 v129, v129
    v_exp_f32 v130, v130
    v_cvt_pk_bf16_f32 v128, v128, v129
    v_exp_f32 v131, v131
    v_exp_f32 v132, v132
    v_cvt_pk_bf16_f32 v129, v130, v131
    v_exp_f32 v133, v133
    v_exp_f32 v134, v134
    v_cvt_pk_bf16_f32 v130, v132, v133
    v_exp_f32 v135, v135
    v_mfma_f32_32x32x16_bf16 v[136:151], v[64:67], v[120:123], v[136:151]
    v_exp_f32 v104, v104
    v_cvt_pk_bf16_f32 v131, v134, v135
    v_exp_f32 v105, v105
    v_exp_f32 v106, v106
    v_mfma_f32_32x32x16_bf16 v[136:151], v[68:71], v[128:131], v[136:151]
    v_exp_f32 v107, v107
    v_cvt_pk_bf16_f32 v104, v104, v105
    v_exp_f32 v108, v108
    v_cvt_pk_bf16_f32 v105, v106, v107
    v_mfma_f32_32x32x16_bf16 v[120:135], v[28:31], v[4:7], v[152:167]
    v_exp_f32 v109, v109
    v_exp_f32 v110, v110
    v_cvt_pk_bf16_f32 v106, v108, v109
    v_exp_f32 v111, v111
    v_exp_f32 v112, v112
    v_cvt_pk_bf16_f32 v107, v110, v111
    v_exp_f32 v113, v113
    v_exp_f32 v114, v114
    v_cvt_pk_bf16_f32 v112, v112, v113
    v_exp_f32 v115, v115
    v_exp_f32 v116, v116
    v_cvt_pk_bf16_f32 v113, v114, v115
    v_exp_f32 v117, v117
    v_exp_f32 v118, v118
    v_cvt_pk_bf16_f32 v114, v116, v117
    v_exp_f32 v119, v119
    v_mfma_f32_32x32x16_bf16 v[136:151], v[72:75], v[104:107], v[136:151]
    v_exp_f32 v120, v120
    v_cvt_pk_bf16_f32 v115, v118, v119
    v_exp_f32 v121, v121
    v_exp_f32 v122, v122
    v_mfma_f32_32x32x16_bf16 v[136:151], v[76:79], v[112:115], v[136:151]
    v_exp_f32 v123, v123
    v_cvt_pk_bf16_f32 v120, v120, v121
    v_exp_f32 v124, v124
    v_cvt_pk_bf16_f32 v121, v122, v123
    v_mfma_f32_32x32x16_bf16 v[104:119], v[32:35], v[4:7], v[152:167]
    v_exp_f32 v125, v125
    v_exp_f32 v126, v126
    v_cvt_pk_bf16_f32 v122, v124, v125
    v_exp_f32 v127, v127
    v_exp_f32 v128, v128
    v_cvt_pk_bf16_f32 v123, v126, v127
    v_exp_f32 v129, v129
    v_exp_f32 v130, v130
    v_cvt_pk_bf16_f32 v128, v128, v129
    v_exp_f32 v131, v131
    v_exp_f32 v132, v132
    v_cvt_pk_bf16_f32 v129, v130, v131
    v_exp_f32 v133, v133
    v_exp_f32 v134, v134
    v_cvt_pk_bf16_f32 v130, v132, v133
    v_exp_f32 v135, v135
    v_mfma_f32_32x32x16_bf16 v[136:151], v[80:83], v[120:123], v[136:151]
    v_exp_f32 v104, v104
    v_cvt_pk_bf16_f32 v131, v134, v135
    v_exp_f32 v105, v105
    v_exp_f32 v106, v106
    v_mfma_f32_32x32x16_bf16 v[136:151], v[84:87], v[128:131], v[136:151]
    v_exp_f32 v107, v107
    v_cvt_pk_bf16_f32 v104, v104, v105
    v_exp_f32 v108, v108
    v_cvt_pk_bf16_f32 v105, v106, v107
    v_mfma_f32_32x32x16_bf16 v[120:135], v[36:39], v[4:7], v[152:167]
    v_exp_f32 v109, v109
    v_exp_f32 v110, v110
    v_cvt_pk_bf16_f32 v106, v108, v109
    v_exp_f32 v111, v111
    v_exp_f32 v112, v112
    v_cvt_pk_bf16_f32 v107, v110, v111
    v_exp_f32 v113, v113
    v_add_u32 v1, 1024, v1
    v_add_u32 v2, 512, v2
    ds_read_b128 v[4:7], v1
    ds_read_b128 v[152:155], v2
    ds_read_b128 v[156:159], v2
    ds_read_b128 v[160:163], v2
    ds_read_b128 v[164:167], v2
    ds_read_addtid_b32 v108
    v_exp_f32 v114, v114
    v_cvt_pk_bf16_f32 v112, v112, v113
    v_exp_f32 v115, v115
    v_exp_f32 v116, v116
    v_cvt_pk_bf16_f32 v113, v114, v115
    v_exp_f32 v117, v117
    v_exp_f32 v118, v118
    v_cvt_pk_bf16_f32 v114, v116, v117
    v_exp_f32 v119, v119
    v_mfma_f32_32x32x16_bf16 v[136:151], v[88:91], v[104:107], v[136:151]
    v_exp_f32 v120, v120
    v_cvt_pk_bf16_f32 v115, v118, v119
    v_exp_f32 v121, v121
    v_exp_f32 v122, v122
    v_mfma_f32_32x32x16_bf16 v[136:151], v[92:95], v[112:115], v[136:151]
    v_exp_f32 v123, v123
    v_cvt_pk_bf16_f32 v120, v120, v121
    v_exp_f32 v124, v124
    v_cvt_pk_bf16_f32 v121, v122, v123
    s_waitcnt lgkmcnt(0)
    v_readfirstlane_b32 s98, v108
    v_mfma_f32_32x32x16_bf16 v[104:119], v[8:11], v[4:7], v[152:167]
    v_exp_f32 v125, v125
    v_exp_f32 v126, v126
    v_cvt_pk_bf16_f32 v122, v124, v125
    v_exp_f32 v127, v127
    v_exp_f32 v128, v128
    v_cvt_pk_bf16_f32 v123, v126, v127
    v_exp_f32 v129, v129
    v_exp_f32 v130, v130
    v_cvt_pk_bf16_f32 v128, v128, v129
    v_exp_f32 v131, v131
    v_exp_f32 v132, v132
    v_cvt_pk_bf16_f32 v129, v130, v131
    v_exp_f32 v133, v133
    v_exp_f32 v134, v134
    v_cvt_pk_bf16_f32 v130, v132, v133
    v_exp_f32 v135, v135
    s_add_u32 s89, s89, 1
    s_cmp_ge_u32 s89, 8
    s_cbranch_scc1 L_sfin
    s_cmp_lt_u32 s98, 138240
    s_cbranch_scc1 L_bloop
    s_setprio 3
    .p2align 3
L_sloop:
    v_mfma_f32_32x32x16_bf16 v[136:151], v[96:99], v[120:123], v[136:151]
    v_exp_f32 v104, v104
    v_cvt_pk_bf16_f32 v131, v134, v135
    v_exp_f32 v105, v105
    v_exp_f32 v106, v106
    v_mfma_f32_32x32x16_bf16 v[136:151], v[100:103], v[128:131], v[136:151]
    v_exp_f32 v107, v107
    v_cvt_pk_bf16_f32 v104, v104, v105
    v_exp_f32 v108, v108
    v_cvt_pk_bf16_f32 v105, v106, v107
    v_mfma_f32_32x32x16_bf16 v[120:135], v[12:15], v[4:7], v[152:167]
    s_setprio 0
    v_exp_f32 v109, v109
    v_exp_f32 v110, v110
    v_cvt_pk_bf16_f32 v106, v108, v109
    v_exp_f32 v111, v111
    v_exp_f32 v112, v112
    v_cvt_pk_bf16_f32 v107, v110, v111
    ds_write_b128 v3, v[136:139]
    ds_write_b128 v3, v[140:143] offset:1024
    ds_write_b32 v0, v144 offset:2048
    ds_write_addtid_b32 v3 offset:1024
    ds_read_b128 v[136:139], v3 offset:9216
    ds_read_b128 v[140:143], v3 offset:10240
    ds_read_b32 v144, v0 offset:11264
    v_add_u32 v3, 9216, v3
    v_add_u32 v0, 9216, v0
    v_exp_f32 v113, v113
    v_exp_f32 v114, v114
    v_cvt_pk_bf16_f32 v112, v112, v113
    v_exp_f32 v115, v115
    v_exp_f32 v116, v116
    s_setprio 3
    v_cvt_pk_bf16_f32 v113, v114, v115
    v_exp_f32 v117, v117
    v_exp_f32 v118, v118
    v_cvt_pk_bf16_f32 v114, v116, v117
    v_exp_f32 v119, v119
    v_exp_f32 v120, v120
    v_cvt_pk_bf16_f32 v115, v118, v119
    v_exp_f32 v121, v121
    v_exp_f32 v122, v122
    s_waitcnt lgkmcnt(0)
    v_mfma_f32_32x32x16_bf16 v[136:151], v[40:43], v[104:107], v[136:151]
    v_exp_f32 v123, v123
    v_cvt_pk_bf16_f32 v120, v120, v121
    v_exp_f32 v124, v124
    v_cvt_pk_bf16_f32 v121, v122, v123
    v_mfma_f32_32x32x16_bf16 v[136:151], v[44:47], v[112:115], v[136:151]
    v_exp_f32 v125, v125
    v_exp_f32 v126, v126
    v_cvt_pk_bf16_f32 v122, v124, v125
    v_exp_f32 v127, v127
    v_mfma_f32_32x32x16_bf16 v[104:119], v[16:19], v[4:7], v[152:167]
    s_setprio 0
    v_exp_f32 v128, v128
    v_cvt_pk_bf16_f32 v123, v126, v127
    v_exp_f32 v129, v129
    v_exp_f32 v130, v130
    v_cvt_pk_bf16_f32 v128, v128, v129
    v_exp_f32 v131, v131
    v_exp_f32 v132, v132
    s_wakeup
    s_setprio 3
    v_cvt_pk_bf16_f32 v129, v130, v131
    v_exp_f32 v133, v133
    v_exp_f32 v134, v134
    v_cvt_pk_bf16_f32 v130, v132, v133
    v_exp_f32 v135, v135
    v_mfma_f32_32x32x16_bf16 v[136:151], v[48:51], v[120:123], v[136:151]
    v_exp_f32 v104, v104
    v_cvt_pk_bf16_f32 v131, v134, v135
    v_exp_f32 v105, v105
    v_exp_f32 v106, v106
    v_mfma_f32_32x32x16_bf16 v[136:151], v[52:55], v[128:131], v[136:151]
    v_exp_f32 v107, v107
    v_cvt_pk_bf16_f32 v104, v104, v105
    v_exp_f32 v108, v108
    v_cvt_pk_bf16_f32 v105, v106, v107
    v_mfma_f32_32x32x16_bf16 v[120:135], v[20:23], v[4:7], v[152:167]
    s_setprio 0
    v_exp_f32 v109, v109
    v_exp_f32 v110, v110
    v_cvt_pk_bf16_f32 v106, v108, v109
    v_exp_f32 v111, v111
    v_exp_f32 v112, v112
    v_cvt_pk_bf16_f32 v107, v110, v111
    v_exp_f32 v113, v113
    v_exp_f32 v114, v114
    v_cvt_pk_bf16_f32 v112, v112, v113
    v_exp_f32 v115, v115
    v_exp_f32 v116, v116
    s_setprio 3
    v_cvt_pk_bf16_f32 v113, v114, v115
    v_exp_f32 v117, v117
    v_exp_f32 v118, v118
    v_cvt_pk_bf16_f32 v114, v116, v117
    v_exp_f32 v119, v119
    v_mfma_f32_32x32x16_bf16 v[136:151], v[56:59], v[104:107], v[136:151]
    v_exp_f32 v120, v120
    v_cvt_pk_bf16_f32 v115, v118, v119
    v_exp_f32 v121, v121
    v_exp_f32 v122, v122
    v_mfma_f32_32x32x16_bf16 v[136:151], v[60:63], v[112:115], v[136:151]
    v_exp_f32 v123, v123
    v_cvt_pk_bf16_f32 v120, v120, v121
    v_exp_f32 v124, v124
    v_cvt_pk_bf16_f32 v121, v122, v123
    v_mfma_f32_32x32x16_bf16 v[104:119], v[24:27], v[4:7], v[152:167]
    s_setprio 0
    v_exp_f32 v125, v125
    v_exp_f32 v126, v126
    v_cvt_pk_bf16_f32 v122, v124, v125
    v_exp_f32 v127, v127
    v_exp_f32 v128, v128
    v_cvt_pk_bf16_f32 v123, v126, v127
    v_exp_f32 v129, v129
    v_exp_f32 v130, v130
    v_cvt_pk_bf16_f32 v128, v128, v129
    v_exp_f32 v131, v131
    v_exp_f32 v132, v132
    s_setprio 3
    v_cvt_pk_bf16_f32 v129, v130, v131
    v_exp_f32 v133, v133
    v_exp_f32 v134, v134
    v_cvt_pk_bf16_f32 v130, v132, v133
    v_exp_f32 v135, v135
    v_mfma_f32_32x32x16_bf16 v[136:151], v[64:67], v[120:123], v[136:151]
    v_exp_f32 v104, v104
    v_cvt_pk_bf16_f32 v131, v134, v135
    v_exp_f32 v105, v105
    v_exp_f32 v106, v106
    v_mfma_f32_32x32x16_bf16 v[136:151], v[68:71], v[128:131], v[136:151]
    v_exp_f32 v107, v107
    v_cvt_pk_bf16_f32 v104, v104, v105
    v_exp_f32 v108, v108
    v_cvt_pk_bf16_f32 v105, v106, v107
    v_mfma_f32_32x32x16_bf16 v[120:135], v[28:31], v[4:7], v[152:167]
    s_setprio 0
    v_exp_f32 v109, v109
    v_exp_f32 v110, v110
    v_cvt_pk_bf16_f32 v106, v108, v109
    v_exp_f32 v111, v111
    v_exp_f32 v112, v112
    v_cvt_pk_bf16_f32 v107, v110, v111
    v_exp_f32 v113, v113
    v_exp_f32 v114, v114
    v_cvt_pk_bf16_f32 v112, v112, v113
    v_exp_f32 v115, v115
    v_exp_f32 v116, v116
    s_setprio 3
    v_cvt_pk_bf16_f32 v113, v114, v115
    v_exp_f32 v117, v117
    v_exp_f32 v118, v118
    v_cvt_pk_bf16_f32 v114, v116, v117
    v_exp_f32 v119, v119
    v_mfma_f32_32x32x16_bf16 v[136:151], v[72:75], v[104:107], v[136:151]
    v_exp_f32 v120, v120
    v_cvt_pk_bf16_f32 v115, v118, v119
    v_exp_f32 v121, v121
    v_exp_f32 v122, v122
    v_mfma_f32_32x32x16_bf16 v[136:151], v[76:79], v[112:115], v[136:151]
    v_exp_f32 v123, v123
    v_cvt_pk_bf16_f32 v120, v120, v121
    v_exp_f32 v124, v124
    v_cvt_pk_bf16_f32 v121, v122, v123
    v_mfma_f32_32x32x16_bf16 v[104:119], v[32:35], v[4:7], v[152:167]
    s_setprio 0
    v_exp_f32 v125, v125
    v_exp_f32 v126, v126
    v_cvt_pk_bf16_f32 v122, v124, v125
    v_exp_f32 v127, v127
    v_exp_f32 v128, v128
    v_cvt_pk_bf16_f32 v123, v126, v127
    v_exp_f32 v129, v129
    v_exp_f32 v130, v130
    v_cvt_pk_bf16_f32 v128, v128, v129
    v_exp_f32 v131, v131
    v_exp_f32 v132, v132
    s_setprio 3
    v_cvt_pk_bf16_f32 v129, v130, v131
    v_exp_f32 v133, v133
    v_exp_f32 v134, v134
    v_cvt_pk_bf16_f32 v130, v132, v133
    v_exp_f32 v135, v135
    v_mfma_f32_32x32x16_bf16 v[136:151], v[80:83], v[120:123], v[136:151]
    v_exp_f32 v104, v104
    v_cvt_pk_bf16_f32 v131, v134, v135
    v_exp_f32 v105, v105
    v_exp_f32 v106, v106
    v_mfma_f32_32x32x16_bf16 v[136:151], v[84:87], v[128:131], v[136:151]
    v_exp_f32 v107, v107
    v_cvt_pk_bf16_f32 v104, v104, v105
    v_exp_f32 v108, v108
    v_cvt_pk_bf16_f32 v105, v106, v107
    v_mfma_f32_32x32x16_bf16 v[120:135], v[36:39], v[4:7], v[152:167]
    s_setprio 0
    v_exp_f32 v109, v109
    v_exp_f32 v110, v110
    v_cvt_pk_bf16_f32 v106, v108, v109
    v_exp_f32 v111, v111
    v_exp_f32 v112, v112
    v_cvt_pk_bf16_f32 v107, v110, v111
    v_exp_f32 v113, v113
    v_add_u32 v1, 1024, v1
    v_add_u32 v2, 512, v2
    ds_read_b128 v[4:7], v1
    ds_read_b128 v[152:155], v2
    ds_read_b128 v[156:159], v2
    ds_read_b128 v[160:163], v2
    ds_read_b128 v[164:167], v2
    v_exp_f32 v114, v114
    v_cvt_pk_bf16_f32 v112, v112, v113
    v_exp_f32 v115, v115
    v_exp_f32 v116, v116
    s_setprio 3
    v_cvt_pk_bf16_f32 v113, v114, v115
    v_exp_f32 v117, v117
    v_exp_f32 v118, v118
    v_cvt_pk_bf16_f32 v114, v116, v117
    v_exp_f32 v119, v119
    v_mfma_f32_32x32x16_bf16 v[136:151], v[88:91], v[104:107], v[136:151]
    v_exp_f32 v120, v120
    v_cvt_pk_bf16_f32 v115, v118, v119
    v_exp_f32 v121, v121
    v_exp_f32 v122, v122
    v_mfma_f32_32x32x16_bf16 v[136:151], v[92:95], v[112:115], v[136:151]
    v_exp_f32 v123, v123
    v_cvt_pk_bf16_f32 v120, v120, v121
    v_exp_f32 v124, v124
    v_cvt_pk_bf16_f32 v121, v122, v123
    s_waitcnt lgkmcnt(0)
    v_mfma_f32_32x32x16_bf16 v[104:119], v[8:11], v[4:7], v[152:167]
    s_setprio 0
    v_exp_f32 v125, v125
    v_exp_f32 v126, v126
    v_cvt_pk_bf16_f32 v122, v124, v125
    v_exp_f32 v127, v127
    v_exp_f32 v128, v128
    v_cvt_pk_bf16_f32 v123, v126, v127
    v_exp_f32 v129, v129
    v_exp_f32 v130, v130
    v_cvt_pk_bf16_f32 v128, v128, v129
    v_exp_f32 v131, v131
    v_exp_f32 v132, v132
    s_setprio 3
    v_cvt_pk_bf16_f32 v129, v130, v131
    v_exp_f32 v133, v133
    v_exp_f32 v134, v134
    v_cvt_pk_bf16_f32 v130, v132, v133
    v_exp_f32 v135, v135
    s_add_u32 s89, s89, 1
    s_cmp_lt_u32 s89, 8
    s_cbranch_scc1 L_sloop
L_sfin:
    v_mfma_f32_32x32x16_bf16 v[136:151], v[96:99], v[120:123], v[136:151]
    v_cvt_pk_bf16_f32 v131, v134, v135
    s_nop 0
    s_nop 0
    v_mfma_f32_32x32x16_bf16 v[136:151], v[100:103], v[128:131], v[136:151]
    s_nop 0
    s_nop 0
    s_nop 0
    s_nop 0
    s_nop 0
    s_nop 0
    s_nop 0
    s_nop 0
    s_nop 0
    s_nop 0
    s_nop 0
    s_nop 0
    ds_write_b128 v3, v[136:139]
    ds_write_b128 v3, v[140:143] offset:1024
    ds_write_b32 v0, v144 offset:2048
    ds_write_addtid_b32 v3 offset:1024
    s_waitcnt lgkmcnt(0)
    s_wakeup
    s_endpgm
L_swait:
    v_mov_b32 v108, m0
L_poll_14:
    ds_read_b32 v109, v108 offset:0
    s_waitcnt lgkmcnt(0)
    v_readfirstlane_b32 s98, v109
    s_cmp_ge_u32 s98, s90
    s_cbranch_scc1 L_poll_14_d
    s_sleep 4
    s_add_u32 s100, s100, 1
    s_cmp_lt_u32 s100, 60000
    s_cbranch_scc1 L_poll_14
L_poll_14_d:
    s_branch L_swait_ret
L_f2:
    s_setprio 3
    s_sub_u32 s88, s3, 4
    s_lshl_b32 s94, s88, 13
    s_add_u32 s92, s94, 5242880
    s_add_u32 s93, s94, 5308416
    s_add_u32 s94, s92, 4096
    s_add_u32 s95, s93, 4096
    s_lshl_b32 s96, s79, 12
    s_add_u32 s96, s96, 5505024
    v_lshl_add_u32 v121, v0, 7, s96
    s_mov_b32 exec_lo, 0xffffffff
    s_mov_b32 exec_hi, 0x0
L_gp_15:
    buffer_load_dword v104, v121, s[64:67], 0 offen sc1
    s_waitcnt vmcnt(0)
    v_cmp_ne_u32 vcc, s71, v104
    s_and_b64 exec, exec, vcc
    s_cbranch_execz L_gp_15_d
    s_sleep 1
    s_add_u32 s100, s100, 1
    s_cmp_lt_u32 s100, 60000
    s_cbranch_scc1 L_gp_15
L_gp_15_d:
    s_mov_b64 exec, -1
    buffer_load_dwordx4 v[8:11], v1, s[64:67], s92 offen offset:0 sc1
    s_mov_b32 exec_lo, 0xffff
    s_mov_b32 exec_hi, 0xffff
    buffer_load_dwordx4 v[40:43], v120, s[64:67], s93 offen offset:0 sc1
    buffer_load_dwordx4 v[44:47], v120, s[64:67], s93 offen offset:512 sc1
    s_mov_b64 exec, -1
    buffer_load_dwordx4 v[12:15], v1, s[64:67], s92 offen offset:1024 sc1
    s_mov_b32 exec_lo, 0xffff
    s_mov_b32 exec_hi, 0xffff
    buffer_load_dwordx4 v[48:51], v120, s[64:67], s93 offen offset:1024 sc1
    buffer_load_dwordx4 v[52:55], v120, s[64:67], s93 offen offset:1536 sc1
    s_mov_b64 exec, -1
    buffer_load_dwordx4 v[16:19], v1, s[64:67], s92 offen offset:2048 sc1
    s_mov_b32 exec_lo, 0xffff
    s_mov_b32 exec_hi, 0xffff
    buffer_load_dwordx4 v[56:59], v120, s[64:67], s93 offen offset:2048 sc1
    buffer_load_dwordx4 v[60:63], v120, s[64:67], s93 offen offset:2560 sc1
    s_mov_b64 exec, -1
    buffer_load_dwordx4 v[20:23], v1, s[64:67], s92 offen offset:3072 sc1
    s_mov_b32 exec_lo, 0xffff
    s_mov_b32 exec_hi, 0xffff
    buffer_load_dwordx4 v[64:67], v120, s[64:67], s93 offen offset:3072 sc1
    buffer_load_dwordx4 v[68:71], v120, s[64:67], s93 offen offset:3584 sc1
    s_mov_b64 exec, -1
    buffer_load_dwordx4 v[24:27], v1, s[64:67], s94 offen offset:0 sc1
    s_mov_b32 exec_lo, 0xffff
    s_mov_b32 exec_hi, 0xffff
    buffer_load_dwordx4 v[72:75], v120, s[64:67], s95 offen offset:0 sc1
    buffer_load_dwordx4 v[76:79], v120, s[64:67], s95 offen offset:512 sc1
    s_mov_b64 exec, -1
    buffer_load_dwordx4 v[28:31], v1, s[64:67], s94 offen offset:1024 sc1
    s_mov_b32 exec_lo, 0xffff
    s_mov_b32 exec_hi, 0xffff
    buffer_load_dwordx4 v[80:83], v120, s[64:67], s95 offen offset:1024 sc1
    buffer_load_dwordx4 v[84:87], v120, s[64:67], s95 offen offset:1536 sc1
    s_mov_b64 exec, -1
    buffer_load_dwordx4 v[32:35], v1, s[64:67], s94 offen offset:2048 sc1
    s_mov_b32 exec_lo, 0xffff
    s_mov_b32 exec_hi, 0xffff
    buffer_load_dwordx4 v[88:91], v120, s[64:67], s95 offen offset:2048 sc1
    buffer_load_dwordx4 v[92:95], v120, s[64:67], s95 offen offset:2560 sc1
    s_mov_b64 exec, -1
    buffer_load_dwordx4 v[36:39], v1, s[64:67], s94 offen offset:3072 sc1
    s_mov_b32 exec_lo, 0xffff
    s_mov_b32 exec_hi, 0xffff
    buffer_load_dwordx4 v[96:99], v120, s[64:67], s95 offen offset:3072 sc1
    buffer_load_dwordx4 v[100:103], v120, s[64:67], s95 offen offset:3584 sc1
    s_mov_b64 exec, -1
    s_mov_b64 exec, 1
    ds_add_u32 v122, v123 offset:8
    s_mov_b64 exec, -1
    s_mul_i32 s90, s79, 2304
    s_add_u32 s90, s90, 73728
    v_add_u32 v3, s90, v1
    v_lshl_add_u32 v0, v0, 2, s90
    v_add_u32 v1, 147456, v1
    s_lshl_b32 s96, s79, 8
    s_add_u32 m0, s96, 160768
L_poll_16:
    ds_read_b32 v104, v122 offset:16
    s_waitcnt lgkmcnt(0)
    v_readfirstlane_b32 s98, v104
    s_cmp_ge_u32 s98, 1
    s_cbranch_scc1 L_poll_16_d
    s_sleep 0
    s_add_u32 s100, s100, 1
    s_cmp_lt_u32 s100, 60000
    s_cbranch_scc1 L_poll_16
L_poll_16_d:
    ds_read_b128 v[4:7], v1
    ds_read_b128 v[152:155], v2
    ds_read_b128 v[156:159], v2
    ds_read_b128 v[160:163], v2
    ds_read_b128 v[164:167], v2
    s_mov_b32 s89, 1
    s_waitcnt vmcnt(23) lgkmcnt(0)
    v_mfma_f32_32x32x16_bf16 v[104:119], v[8:11], v[4:7], v[152:167]
    s_nop 0
    s_nop 0
    s_nop 0
    s_nop 0
    s_nop 0
    s_nop 0
    s_nop 0
    s_nop 0
    s_nop 0
    s_nop 0
    s_nop 0
    s_nop 0
    v_exp_f32 v104, v104
    v_exp_f32 v105, v105
    v_exp_f32 v106, v106
    v_exp_f32 v107, v107
    v_cvt_pk_bf16_f32 v104, v104, v105
    v_exp_f32 v108, v108
    v_cvt_pk_bf16_f32 v105, v106, v107
    s_waitcnt vmcnt(20)
    v_mfma_f32_32x32x16_bf16 v[120:135], v[12:15], v[4:7], v[152:167]
    s_setprio 2
    v_exp_f32 v109, v109
    v_exp_f32 v110, v110
    v_cvt_pk_bf16_f32 v106, v108, v109
    v_exp_f32 v111, v111
    v_exp_f32 v112, v112
    v_cvt_pk_bf16_f32 v107, v110, v111
    v_exp_f32 v113, v113
    v_exp_f32 v114, v114
    v_cvt_pk_bf16_f32 v112, v112, v113
    v_exp_f32 v115, v115
    v_exp_f32 v116, v116
    s_setprio 3
    v_cvt_pk_bf16_f32 v113, v114, v115
    v_exp_f32 v117, v117
    v_exp_f32 v118, v118
    v_cvt_pk_bf16_f32 v114, v116, v117
    v_exp_f32 v119, v119
    s_waitcnt vmcnt(17)
    v_mfma_f32_32x32x16_bf16 v[136:151], v[40:43], v[104:107], 0
    v_exp_f32 v120, v120
    v_cvt_pk_bf16_f32 v115, v118, v119
    v_exp_f32 v121, v121
    v_exp_f32 v122, v122
    v_mfma_f32_32x32x16_bf16 v[136:151], v[44:47], v[112:115], v[136:151]
    v_exp_f32 v123, v123
    v_cvt_pk_bf16_f32 v120, v120, v121
    v_exp_f32 v124, v124
    v_cvt_pk_bf16_f32 v121, v122, v123
    v_mfma_f32_32x32x16_bf16 v[104:119], v[16:19], v[4:7], v[152:167]
    s_setprio 2
    v_exp_f32 v125, v125
    v_exp_f32 v126, v126
    v_cvt_pk_bf16_f32 v122, v124, v125
    v_exp_f32 v127, v127
    v_exp_f32 v128, v128
    v_cvt_pk_bf16_f32 v123, v126, v127
    v_exp_f32 v129, v129
    v_exp_f32 v130, v130
    v_cvt_pk_bf16_f32 v128, v128, v129
    v_exp_f32 v131, v131
    v_exp_f32 v132, v132
    s_setprio 3
    v_cvt_pk_bf16_f32 v129, v130, v131
    v_exp_f32 v133, v133
    v_exp_f32 v134, v134
    v_cvt_pk_bf16_f32 v130, v132, v133
    v_exp_f32 v135, v135
    s_waitcnt vmcnt(14)
    v_mfma_f32_32x32x16_bf16 v[136:151], v[48:51], v[120:123], v[136:151]
    v_exp_f32 v104, v104
    v_cvt_pk_bf16_f32 v131, v134, v135
    v_exp_f32 v105, v105
    v_exp_f32 v106, v106
    v_mfma_f32_32x32x16_bf16 v[136:151], v[52:55], v[128:131], v[136:151]
    v_exp_f32 v107, v107
    v_cvt_pk_bf16_f32 v104, v104, v105
    v_exp_f32 v108, v108
    v_cvt_pk_bf16_f32 v105, v106, v107
    v_mfma_f32_32x32x16_bf16 v[120:135], v[20:23], v[4:7], v[152:167]
    s_setprio 2
    v_exp_f32 v109, v109
    v_exp_f32 v110, v110
    v_cvt_pk_bf16_f32 v106, v108, v109
    v_exp_f32 v111, v111
    v_exp_f32 v112, v112
    v_cvt_pk_bf16_f32 v107, v110, v111
    v_exp_f32 v113, v113
    v_exp_f32 v114, v114
    v_cvt_pk_bf16_f32 v112, v112, v113
    v_exp_f32 v115, v115
    v_exp_f32 v116, v116
    s_setprio 3
    v_cvt_pk_bf16_f32 v113, v114, v115
    v_exp_f32 v117, v117
    v_exp_f32 v118, v118
    v_cvt_pk_bf16_f32 v114, v116, v117
    v_exp_f32 v119, v119
    s_waitcnt vmcnt(11)
    v_mfma_f32_32x32x16_bf16 v[136:151], v[56:59], v[104:107], v[136:151]
    v_exp_f32 v120, v120
    v_cvt_pk_bf16_f32 v115, v118, v119
    v_exp_f32 v121, v121
    v_exp_f32 v122, v122
    v_mfma_f32_32x32x16_bf16 v[136:151], v[60:63], v[112:115], v[136:151]
    v_exp_f32 v123, v123
    v_cvt_pk_bf16_f32 v120, v120, v121
    v_exp_f32 v124, v124
    v_cvt_pk_bf16_f32 v121, v122, v123
    v_mfma_f32_32x32x16_bf16 v[104:119], v[24:27], v[4:7], v[152:167]
    s_setprio 2
    v_exp_f32 v125, v125
    v_exp_f32 v126, v126
    v_cvt_pk_bf16_f32 v122, v124, v125
    v_exp_f32 v127, v127
    v_exp_f32 v128, v128
    v_cvt_pk_bf16_f32 v123, v126, v127
    v_exp_f32 v129, v129
    v_exp_f32 v130, v130
    v_cvt_pk_bf16_f32 v128, v128, v129
    v_exp_f32 v131, v131
    v_exp_f32 v132, v132
    s_setprio 3
    v_cvt_pk_bf16_f32 v129, v130, v131
    v_exp_f32 v133, v133
    v_exp_f32 v134, v134
    v_cvt_pk_bf16_f32 v130, v132, v133
    v_exp_f32 v135, v135
    s_waitcnt vmcnt(8)
    v_mfma_f32_32x32x16_bf16 v[136:151], v[64:67], v[120:123], v[136:151]
    v_exp_f32 v104, v104
    v_cvt_pk_bf16_f32 v131, v134, v135
    v_exp_f32 v105, v105
    v_exp_f32 v106, v106
    v_mfma_f32_32x32x16_bf16 v[136:151], v[68:71], v[128:131], v[136:151]
    v_exp_f32 v107, v107
    v_cvt_pk_bf16_f32 v104, v104, v105
    v_exp_f32 v108, v108
    v_cvt_pk_bf16_f32 v105, v106, v107
    v_mfma_f32_32x32x16_bf16 v[120:135], v[28:31], v[4:7], v[152:167]
    s_setprio 2
    v_exp_f32 v109, v109
    v_exp_f32 v110, v110
    v_cvt_pk_bf16_f32 v106, v108, v109
    v_exp_f32 v111, v111
    v_exp_f32 v112, v112
    v_cvt_pk_bf16_f32 v107, v110, v111
    v_exp_f32 v113, v113
    v_exp_f32 v114, v114
    v_cvt_pk_bf16_f32 v112, v112, v113
    v_exp_f32 v115, v115
    v_exp_f32 v116, v116
    s_setprio 3
    v_cvt_pk_bf16_f32 v113, v114, v115
    v_exp_f32 v117, v117
    v_exp_f32 v118, v118
    v_cvt_pk_bf16_f32 v114, v116, v117
    v_exp_f32 v119, v119
    s_waitcnt vmcnt(5)
    v_mfma_f32_32x32x16_bf16 v[136:151], v[72:75], v[104:107], v[136:151]
    v_exp_f32 v120, v120
    v_cvt_pk_bf16_f32 v115, v118, v119
    v_exp_f32 v121, v121
    v_exp_f32 v122, v122
    v_mfma_f32_32x32x16_bf16 v[136:151], v[76:79], v[112:115], v[136:151]
    v_exp_f32 v123, v123
    v_cvt_pk_bf16_f32 v120, v120, v121
    v_exp_f32 v124, v124
    v_cvt_pk_bf16_f32 v121, v122, v123
    v_mfma_f32_32x32x16_bf16 v[104:119], v[32:35], v[4:7], v[152:167]
    s_setprio 2
    v_exp_f32 v125, v125
    v_exp_f32 v126, v126
    v_cvt_pk_bf16_f32 v122, v124, v125
    v_exp_f32 v127, v127
    v_exp_f32 v128, v128
    v_cvt_pk_bf16_f32 v123, v126, v127
    v_exp_f32 v129, v129
    v_exp_f32 v130, v130
    v_cvt_pk_bf16_f32 v128, v128, v129
    v_exp_f32 v131, v131
    v_exp_f32 v132, v132
    s_setprio 3
    v_cvt_pk_bf16_f32 v129, v130, v131
    v_exp_f32 v133, v133
    v_exp_f32 v134, v134
    v_cvt_pk_bf16_f32 v130, v132, v133
    v_exp_f32 v135, v135
    s_waitcnt vmcnt(2)
    v_mfma_f32_32x32x16_bf16 v[136:151], v[80:83], v[120:123], v[136:151]
    v_exp_f32 v104, v104
    v_cvt_pk_bf16_f32 v131, v134, v135
    v_exp_f32 v105, v105
    v_exp_f32 v106, v106
    v_mfma_f32_32x32x16_bf16 v[136:151], v[84:87], v[128:131], v[136:151]
    v_exp_f32 v107, v107
    v_cvt_pk_bf16_f32 v104, v104, v105
    v_exp_f32 v108, v108
    v_cvt_pk_bf16_f32 v105, v106, v107
    v_mfma_f32_32x32x16_bf16 v[120:135], v[36:39], v[4:7], v[152:167]
    s_setprio 2
    v_exp_f32 v109, v109
    v_exp_f32 v110, v110
    v_cvt_pk_bf16_f32 v106, v108, v109
    v_exp_f32 v111, v111
    v_exp_f32 v112, v112
    v_cvt_pk_bf16_f32 v107, v110, v111
    v_exp_f32 v113, v113
    v_mov_b32 v108, 160256
L_poll_17:
    ds_read_b32 v109, v108 offset:4
    s_waitcnt lgkmcnt(0)
    v_readfirstlane_b32 s98, v109
    s_cmp_ge_u32 s98, 8
    s_cbranch_scc1 L_poll_17_d
    s_sleep 1
    s_add_u32 s100, s100, 1
    s_cmp_lt_u32 s100, 60000
    s_cbranch_scc1 L_poll_17
L_poll_17_d:
    v_add_u32 v1, 1024, v1
    v_add_u32 v2, 512, v2
    ds_read_b128 v[4:7], v1
    ds_read_b128 v[152:155], v2
    ds_read_b128 v[156:159], v2
    ds_read_b128 v[160:163], v2
    ds_read_b128 v[164:167], v2
    v_exp_f32 v114, v114
    v_cvt_pk_bf16_f32 v112, v112, v113
    v_exp_f32 v115, v115
    v_exp_f32 v116, v116
    s_setprio 3
    v_cvt_pk_bf16_f32 v113, v114, v115
    v_exp_f32 v117, v117
    v_exp_f32 v118, v118
    v_cvt_pk_bf16_f32 v114, v116, v117
    v_exp_f32 v119, v119
    s_waitcnt vmcnt(0)
    v_mfma_f32_32x32x16_bf16 v[136:151], v[88:91], v[104:107], v[136:151]
    v_exp_f32 v120, v120
    v_cvt_pk_bf16_f32 v115, v118, v119
    v_exp_f32 v121, v121
    v_exp_f32 v122, v122
    v_mfma_f32_32x32x16_bf16 v[136:151], v[92:95], v[112:115], v[136:151]
    v_exp_f32 v123, v123
    v_cvt_pk_bf16_f32 v120, v120, v121
    v_exp_f32 v124, v124
    v_cvt_pk_bf16_f32 v121, v122, v123
    s_waitcnt lgkmcnt(0)
    v_mfma_f32_32x32x16_bf16 v[104:119], v[8:11], v[4:7], v[152:167]
    s_setprio 2
    v_exp_f32 v125, v125
    v_exp_f32 v126, v126
    v_cvt_pk_bf16_f32 v122, v124, v125
    v_exp_f32 v127, v127
    v_exp_f32 v128, v128
    v_cvt_pk_bf16_f32 v123, v126, v127
    v_exp_f32 v129, v129
    v_exp_f32 v130, v130
    v_cvt_pk_bf16_f32 v128, v128, v129
    v_exp_f32 v131, v131
    v_exp_f32 v132, v132
    s_setprio 3
    v_cvt_pk_bf16_f32 v129, v130, v131
    v_exp_f32 v133, v133
    v_exp_f32 v134, v134
    v_cvt_pk_bf16_f32 v130, v132, v133
    v_exp_f32 v135, v135
    .p2align 3
L_floop:
    v_mfma_f32_32x32x16_bf16 v[136:151], v[96:99], v[120:123], v[136:151]
    v_exp_f32 v104, v104
    v_cvt_pk_bf16_f32 v131, v134, v135
    v_exp_f32 v105, v105
    v_exp_f32 v106, v106
    v_mfma_f32_32x32x16_bf16 v[136:151], v[100:103], v[128:131], v[136:151]
    v_exp_f32 v107, v107
    v_cvt_pk_bf16_f32 v104, v104, v105
    v_exp_f32 v108, v108
    v_cvt_pk_bf16_f32 v105, v106, v107
    v_mfma_f32_32x32x16_bf16 v[120:135], v[12:15], v[4:7], v[152:167]
    s_setprio 2
    v_exp_f32 v109, v109
    v_exp_f32 v110, v110
    v_cvt_pk_bf16_f32 v106, v108, v109
    v_exp_f32 v111, v111
    v_exp_f32 v112, v112
    v_cvt_pk_bf16_f32 v107, v110, v111
    ds_write_b128 v3, v[136:139]
    ds_write_b128 v3, v[140:143] offset:1024
    ds_write_b32 v0, v144 offset:2048
    ds_write_addtid_b32 v3 offset:0
    v_add_u32 v3, 9216, v3
    v_add_u32 v0, 9216, v0
    v_exp_f32 v113, v113
    v_exp_f32 v114, v114
    v_cvt_pk_bf16_f32 v112, v112, v113
    v_exp_f32 v115, v115
    v_exp_f32 v116, v116
    s_setprio 3
    v_cvt_pk_bf16_f32 v113, v114, v115
    v_exp_f32 v117, v117
    v_exp_f32 v118, v118
    v_cvt_pk_bf16_f32 v114, v116, v117
    v_exp_f32 v119, v119
    v_mfma_f32_32x32x16_bf16 v[136:151], v[40:43], v[104:107], 0
    v_exp_f32 v120, v120
    v_cvt_pk_bf16_f32 v115, v118, v119
    v_exp_f32 v121, v121
    v_exp_f32 v122, v122
    v_mfma_f32_32x32x16_bf16 v[136:151], v[44:47], v[112:115], v[136:151]
    v_exp_f32 v123, v123
    v_cvt_pk_bf16_f32 v120, v120, v121
    v_exp_f32 v124, v124
    v_cvt_pk_bf16_f32 v121, v122, v123
    v_mfma_f32_32x32x16_bf16 v[104:119], v[16:19], v[4:7], v[152:167]
    s_setprio 2
    v_exp_f32 v125, v125
    v_exp_f32 v126, v126
    v_cvt_pk_bf16_f32 v122, v124, v125
    v_exp_f32 v127, v127
    v_exp_f32 v128, v128
    v_cvt_pk_bf16_f32 v123, v126, v127
    v_exp_f32 v129, v129
    v_exp_f32 v130, v130
    v_cvt_pk_bf16_f32 v128, v128, v129
    v_exp_f32 v131, v131
    v_exp_f32 v132, v132
    s_setprio 3
    v_cvt_pk_bf16_f32 v129, v130, v131
    v_exp_f32 v133, v133
    v_exp_f32 v134, v134
    v_cvt_pk_bf16_f32 v130, v132, v133
    v_exp_f32 v135, v135
    v_mfma_f32_32x32x16_bf16 v[136:151], v[48:51], v[120:123], v[136:151]
    v_exp_f32 v104, v104
    v_cvt_pk_bf16_f32 v131, v134, v135
    v_exp_f32 v105, v105
    v_exp_f32 v106, v106
    v_mfma_f32_32x32x16_bf16 v[136:151], v[52:55], v[128:131], v[136:151]
    v_exp_f32 v107, v107
    v_cvt_pk_bf16_f32 v104, v104, v105
    v_exp_f32 v108, v108
    v_cvt_pk_bf16_f32 v105, v106, v107
    v_mfma_f32_32x32x16_bf16 v[120:135], v[20:23], v[4:7], v[152:167]
    s_setprio 2
    v_exp_f32 v109, v109
    v_exp_f32 v110, v110
    v_cvt_pk_bf16_f32 v106, v108, v109
    v_exp_f32 v111, v111
    v_exp_f32 v112, v112
    v_cvt_pk_bf16_f32 v107, v110, v111
    v_exp_f32 v113, v113
    v_exp_f32 v114, v114
    v_cvt_pk_bf16_f32 v112, v112, v113
    v_exp_f32 v115, v115
    v_exp_f32 v116, v116
    s_setprio 3
    v_cvt_pk_bf16_f32 v113, v114, v115
    v_exp_f32 v117, v117
    v_exp_f32 v118, v118
    v_cvt_pk_bf16_f32 v114, v116, v117
    v_exp_f32 v119, v119
    v_mfma_f32_32x32x16_bf16 v[136:151], v[56:59], v[104:107], v[136:151]
    v_exp_f32 v120, v120
    v_cvt_pk_bf16_f32 v115, v118, v119
    v_exp_f32 v121, v121
    v_exp_f32 v122, v122
    v_mfma_f32_32x32x16_bf16 v[136:151], v[60:63], v[112:115], v[136:151]
    v_exp_f32 v123, v123
    v_cvt_pk_bf16_f32 v120, v120, v121
    v_exp_f32 v124, v124
    v_cvt_pk_bf16_f32 v121, v122, v123
    v_mfma_f32_32x32x16_bf16 v[104:119], v[24:27], v[4:7], v[152:167]
    s_setprio 2
    v_exp_f32 v125, v125
    v_exp_f32 v126, v126
    v_cvt_pk_bf16_f32 v122, v124, v125
    v_exp_f32 v127, v127
    v_exp_f32 v128, v128
    v_cvt_pk_bf16_f32 v123, v126, v127
    v_exp_f32 v129, v129
    v_exp_f32 v130, v130
    v_cvt_pk_bf16_f32 v128, v128, v129
    v_exp_f32 v131, v131
    v_exp_f32 v132, v132
    s_setprio 3
    v_cvt_pk_bf16_f32 v129, v130, v131
    v_exp_f32 v133, v133
    v_exp_f32 v134, v134
    v_cvt_pk_bf16_f32 v130, v132, v133
    v_exp_f32 v135, v135
    v_mfma_f32_32x32x16_bf16 v[136:151], v[64:67], v[120:123], v[136:151]
    v_exp_f32 v104, v104
    v_cvt_pk_bf16_f32 v131, v134, v135
    v_exp_f32 v105, v105
    v_exp_f32 v106, v106
    v_mfma_f32_32x32x16_bf16 v[136:151], v[68:71], v[128:131], v[136:151]
    v_exp_f32 v107, v107
    v_cvt_pk_bf16_f32 v104, v104, v105
    v_exp_f32 v108, v108
    v_cvt_pk_bf16_f32 v105, v106, v107
    v_mfma_f32_32x32x16_bf16 v[120:135], v[28:31], v[4:7], v[152:167]
    s_setprio 2
    v_exp_f32 v109, v109
    v_exp_f32 v110, v110
    v_cvt_pk_bf16_f32 v106, v108, v109
    v_exp_f32 v111, v111
    v_exp_f32 v112, v112
    v_cvt_pk_bf16_f32 v107, v110, v111
    v_exp_f32 v113, v113
    v_exp_f32 v114, v114
    v_cvt_pk_bf16_f32 v112, v112, v113
    v_exp_f32 v115, v115
    v_exp_f32 v116, v116
    s_setprio 3
    v_cvt_pk_bf16_f32 v113, v114, v115
    v_exp_f32 v117, v117
    v_exp_f32 v118, v118
    v_cvt_pk_bf16_f32 v114, v116, v117
    v_exp_f32 v119, v119
    v_mfma_f32_32x32x16_bf16 v[136:151], v[72:75], v[104:107], v[136:151]
    v_exp_f32 v120, v120
    v_cvt_pk_bf16_f32 v115, v118, v119
    v_exp_f32 v121, v121
    v_exp_f32 v122, v122
    v_mfma_f32_32x32x16_bf16 v[136:151], v[76:79], v[112:115], v[136:151]
    v_exp_f32 v123, v123
    v_cvt_pk_bf16_f32 v120, v120, v121
    v_exp_f32 v124, v124
    v_cvt_pk_bf16_f32 v121, v122, v123
    v_mfma_f32_32x32x16_bf16 v[104:119], v[32:35], v[4:7], v[152:167]
    s_setprio 2
    v_exp_f32 v125, v125
    v_exp_f32 v126, v126
    v_cvt_pk_bf16_f32 v122, v124, v125
    v_exp_f32 v127, v127
    v_exp_f32 v128, v128
    v_cvt_pk_bf16_f32 v123, v126, v127
    v_exp_f32 v129, v129
    v_exp_f32 v130, v130
    v_cvt_pk_bf16_f32 v128, v128, v129
    v_exp_f32 v131, v131
    v_exp_f32 v132, v132
    s_setprio 3
    v_cvt_pk_bf16_f32 v129, v130, v131
    v_exp_f32 v133, v133
    v_exp_f32 v134, v134
    v_cvt_pk_bf16_f32 v130, v132, v133
    v_exp_f32 v135, v135
    v_mfma_f32_32x32x16_bf16 v[136:151], v[80:83], v[120:123], v[136:151]
    v_exp_f32 v104, v104
    v_cvt_pk_bf16_f32 v131, v134, v135
    v_exp_f32 v105, v105
    v_exp_f32 v106, v106
    v_mfma_f32_32x32x16_bf16 v[136:151], v[84:87], v[128:131], v[136:151]
    v_exp_f32 v107, v107
    v_cvt_pk_bf16_f32 v104, v104, v105
    v_exp_f32 v108, v108
    v_cvt_pk_bf16_f32 v105, v106, v107
    v_mfma_f32_32x32x16_bf16 v[120:135], v[36:39], v[4:7], v[152:167]
    s_setprio 2
    v_exp_f32 v109, v109
    v_exp_f32 v110, v110
    v_cvt_pk_bf16_f32 v106, v108, v109
    v_exp_f32 v111, v111
    v_exp_f32 v112, v112
    v_cvt_pk_bf16_f32 v107, v110, v111
    v_exp_f32 v113, v113
    v_add_u32 v1, 1024, v1
    v_add_u32 v2, 512, v2
    ds_read_b128 v[4:7], v1
    ds_read_b128 v[152:155], v2
    ds_read_b128 v[156:159], v2
    ds_read_b128 v[160:163], v2
    ds_read_b128 v[164:167], v2
    v_exp_f32 v114, v114
    v_cvt_pk_bf16_f32 v112, v112, v113
    v_exp_f32 v115, v115
    v_exp_f32 v116, v116
    s_setprio 3
    v_cvt_pk_bf16_f32 v113, v114, v115
    v_exp_f32 v117, v117
    v_exp_f32 v118, v118
    v_cvt_pk_bf16_f32 v114, v116, v117
    v_exp_f32 v119, v119
    v_mfma_f32_32x32x16_bf16 v[136:151], v[88:91], v[104:107], v[136:151]
    v_exp_f32 v120, v120
    v_cvt_pk_bf16_f32 v115, v118, v119
    v_exp_f32 v121, v121
    v_exp_f32 v122, v122
    v_mfma_f32_32x32x16_bf16 v[136:151], v[92:95], v[112:115], v[136:151]
    v_exp_f32 v123, v123
    v_cvt_pk_bf16_f32 v120, v120, v121
    v_exp_f32 v124, v124
    v_cvt_pk_bf16_f32 v121, v122, v123
    s_waitcnt lgkmcnt(0)
    v_mfma_f32_32x32x16_bf16 v[104:119], v[8:11], v[4:7], v[152:167]
    s_setprio 2
    v_exp_f32 v125, v125
    v_exp_f32 v126, v126
    v_cvt_pk_bf16_f32 v122, v124, v125
    v_exp_f32 v127, v127
    v_exp_f32 v128, v128
    v_cvt_pk_bf16_f32 v123, v126, v127
    v_exp_f32 v129, v129
    v_exp_f32 v130, v130
    v_cvt_pk_bf16_f32 v128, v128, v129
    v_exp_f32 v131, v131
    v_exp_f32 v132, v132
    s_setprio 3
    v_cvt_pk_bf16_f32 v129, v130, v131
    v_exp_f32 v133, v133
    v_exp_f32 v134, v134
    v_cvt_pk_bf16_f32 v130, v132, v133
    v_exp_f32 v135, v135
    s_add_u32 s89, s89, 1
    s_cmp_lt_u32 s89, 8
    s_cbranch_scc1 L_floop
    v_mfma_f32_32x32x16_bf16 v[136:151], v[96:99], v[120:123], v[136:151]
    v_cvt_pk_bf16_f32 v131, v134, v135
    s_nop 0
    s_nop 0
    v_mfma_f32_32x32x16_bf16 v[136:151], v[100:103], v[128:131], v[136:151]
    s_nop 0
    s_nop 0
    s_nop 0
    s_nop 0
    s_nop 0
    s_nop 0
    s_nop 0
    s_nop 0
    s_nop 0
    s_nop 0
    s_nop 0
    s_nop 0
    ds_write_b128 v3, v[136:139]
    ds_write_b128 v3, v[140:143] offset:1024
    ds_write_b32 v0, v144 offset:2048
    ds_write_addtid_b32 v3 offset:0
    s_waitcnt lgkmcnt(0)
    s_wakeup
    s_branch L_f3
L_h2:
    s_load_dwordx2 s[48:49], s[0:1], 40
    s_mov_b32 s50, 0x200000
    s_mov_b32 s51, 0x20000
    s_load_dwordx2 s[52:53], s[0:1], 48
    s_mov_b32 s54, 0x180000
    s_mov_b32 s55, 0x20000
    s_load_dwordx2 s[56:57], s[0:1], 56
    s_mov_b32 s58, 0x80000
    s_mov_b32 s59, 0x20000
    s_load_dwordx2 s[44:45], s[0:1], 32
    s_mov_b32 s46, 0x80000
    s_mov_b32 s47, 0x20000
    s_load_dwordx2 s[60:61], s[0:1], 64
    s_mov_b32 s62, 0x400000
    s_mov_b32 s63, 0x20000
    v_lshrrev_b32 v20, 3, v0
    v_and_b32 v21, 7, v0
    v_lshrrev_b32 v22, 1, v20
    v_xor_b32 v23, v21, v22
    v_lshlrev_b32 v23, 4, v23
    v_lshl_add_u32 v1, v20, 11, v23
    v_xor_b32 v2, 64, v1
    s_lshl_b32 s92, s79, 5
    v_xor_b32 v3, s92, v1
    v_and_b32 v22, 1, v22
    v_lshlrev_b32 v22, 2, v22
    v_xor_b32 v23, v21, v22
    v_lshlrev_b32 v23, 4, v23
    v_mul_u32_u24 v20, 3072, v20
    v_add_u32 v4, v20, v23
    v_xor_b32 v16, 32, v4
    s_and_b32 s92, s79, 1
    s_lshr_b32 s93, s79, 1
    s_lshl_b32 s93, s93, 10
    s_lshl_b32 s80, s72, 16
    s_max_u32 s81, s80, 16384
    s_sub_u32 s81, s81, 16384
    s_add_u32 s80, s80, s93
    s_add_u32 s81, s81, s93
    s_lshl_b32 s93, s92, 15
    s_add_u32 s80, s80, s93
    s_lshl_b32 s93, s92, 13
    s_add_u32 s81, s81, s93
    s_mul_i32 s82, s79, 49152
    s_lshl_b32 s93, s73, 7
    s_add_u32 s82, s82, s93
    s_lshl_b32 s83, s72, 1
    s_add_u32 s83, s83, s73
    s_lshl_b32 s86, s79, 11
    s_add_u32 s84, s86, 26624
    s_lshl_b32 s85, s79, 9
    s_add_u32 s85, s85, 24576
    v_and_b32 v20, 31, v0
    v_lshrrev_b32 v21, 5, v0
    v_bfe_u32 v22, v0, 1, 3
    v_xor_b32 v22, v22, v21
    v_lshlrev_b32 v22, 4, v22
    v_lshl_add_u32 v22, v20, 7, v22
    s_lshl_b32 s92, s92, 12
    s_add_u32 s92, s92, 26624
    v_add_u32 v8, s92, v22
    v_xor_b32 v9, 32, v8
    v_xor_b32 v10, 64, v8
    v_xor_b32 v11, 96, v8
    v_bfe_u32 v20, v0, 2, 2
    v_and_b32 v23, 3, v0
    v_and_b32 v17, 2, v20
    v_or_b32 v18, v17, v21
    v_bfe_u32 v19, v0, 4, 1
    s_and_b32 s92, s79, 2
    v_or_b32 v19, s92, v19
    v_xor_b32 v18, v18, v19
    v_lshl_add_u32 v22, v21, 3, v20
    v_lshlrev_b32 v22, 7, v22
    v_lshl_add_u32 v22, v18, 5, v22
    v_lshl_add_u32 v12, v23, 3, v22
    v_lshrrev_b32 v21, 4, v0
    v_bfe_u32 v22, v0, 1, 3
    v_xor_b32 v22, v22, v21
    v_lshlrev_b32 v22, 4, v22
    v_and_b32 v19, 15, v0
    v_lshl_add_u32 v22, v19, 7, v22
    v_add_u32 v13, 24576, v22
    v_xor_b32 v14, 64, v13
    v_and_b32 v18, 1, v21
    v_or_b32 v18, v17, v18
    v_xor_b32 v18, s79, v18
    v_lshl_add_u32 v22, v21, 3, v20
    v_lshlrev_b32 v22, 7, v22
    v_lshl_add_u32 v22, v18, 5, v22
    v_lshl_add_u32 v15, v23, 3, v22
    v_mov_b32 v80, 0xf149f2ca
    v_mov_b32 v81, v80
    v_mov_b32 v82, v80
    v_mov_b32 v83, v80
    v_mov_b32 v84, v80
    v_mov_b32 v85, v80
    v_mov_b32 v86, v80
    v_mov_b32 v87, v80
    v_mov_b32 v88, v80
    v_mov_b32 v89, v80
    v_mov_b32 v90, v80
    v_mov_b32 v91, v80
    v_mov_b32 v92, v80
    v_mov_b32 v93, v80
    v_mov_b32 v94, v80
    v_mov_b32 v95, v80
    v_mov_b32 v96, v80
    v_mov_b32 v97, v80
    v_mov_b32 v98, v80
    v_mov_b32 v99, v80
    s_mov_b32 exec_lo, 0xff
    s_mov_b32 exec_hi, 0xff0
    v_mov_b32 v80, 0
    s_mov_b32 exec_lo, 0x1fe
    s_mov_b32 exec_hi, 0x1fe0
    v_mov_b32 v81, 0
    s_mov_b32 exec_lo, 0x3fc
    s_mov_b32 exec_hi, 0x3fc0
    v_mov_b32 v82, 0
    s_mov_b32 exec_lo, 0x7f8
    s_mov_b32 exec_hi, 0x7f80
    v_mov_b32 v83, 0
    s_mov_b32 exec_lo, 0xff00
    s_mov_b32 exec_hi, 0xff000
    v_mov_b32 v84, 0
    s_mov_b32 exec_lo, 0x1fe00
    s_mov_b32 exec_hi, 0x1fe000
    v_mov_b32 v85, 0
    s_mov_b32 exec_lo, 0x3fc00
    s_mov_b32 exec_hi, 0x3fc000
    v_mov_b32 v86, 0
    s_mov_b32 exec_lo, 0x7f800
    s_mov_b32 exec_hi, 0x7f8000
    v_mov_b32 v87, 0
    s_mov_b32 exec_lo, 0xff0000
    s_mov_b32 exec_hi, 0xff00000
    v_mov_b32 v88, 0
    s_mov_b32 exec_lo, 0x1fe0000
    s_mov_b32 exec_hi, 0x1fe00000
    v_mov_b32 v89, 0
    s_mov_b32 exec_lo, 0x3fc0000
    s_mov_b32 exec_hi, 0x3fc00000
    v_mov_b32 v90, 0
    s_mov_b32 exec_lo, 0x7f80000
    s_mov_b32 exec_hi, 0x7f800000
    v_mov_b32 v91, 0
    s_mov_b32 exec_lo, 0xff000000
    s_mov_b32 exec_hi, 0xf0000000
    v_mov_b32 v92, 0
    s_mov_b32 exec_lo, 0xfe000000
    s_mov_b32 exec_hi, 0xe0000000
    v_mov_b32 v93, 0
    s_mov_b32 exec_lo, 0xfc000000
    s_mov_b32 exec_hi, 0xc0000000
    v_mov_b32 v94, 0
    s_mov_b32 exec_lo, 0xf8000000
    s_mov_b32 exec_hi, 0x80000000
    v_mov_b32 v95, 0
    s_cmp_eq_u32 s72, 0
    s_cbranch_scc1 L_nomp
    s_mov_b32 exec_lo, 0x0
    s_mov_b32 exec_hi, 0xf
    v_mov_b32 v96, 0
    s_mov_b32 exec_lo, 0x1
    s_mov_b32 exec_hi, 0x1f
    v_mov_b32 v97, 0
    s_mov_b32 exec_lo, 0x3
    s_mov_b32 exec_hi, 0x3f
    v_mov_b32 v98, 0
    s_mov_b32 exec_lo, 0x7
    s_mov_b32 exec_hi, 0x7f
    v_mov_b32 v99, 0
L_nomp:
    s_mov_b64 exec, -1
    v_lshrrev_b32 v30, 5, v0
    v_bfe_u32 v31, v0, 2, 2
    v_lshl_add_u32 v31, v30, 2, v31
    v_lshlrev_b32 v164, 7, v31
    v_bfe_u32 v31, v0, 3, 1
    v_lshl_add_u32 v164, v31, 6, v164
    v_and_b32 v31, 1, v0
    v_lshl_add_u32 v164, v31, 5, v164
    v_bfe_u32 v31, v0, 1, 1
    v_lshl_add_u32 v164, v31, 3, v164
    v_bfe_u32 v31, v0, 4, 1
    v_lshl_add_u32 v164, v31, 4, v164
    v_and_b32 v167, 31, v0
    v_lshlrev_b32 v167, 11, v167
    v_lshl_add_u32 v167, v30, 5, v167
    v_lshlrev_b32 v166, 2, v0
    v_lshlrev_b32 v165, 7, v0
    v_lshlrev_b32 v31, 4, v0
    v_add_u32 v31, 162816, v31
    ds_write_b128 v31, v[164:167]
    v_lshlrev_b32 v22, 4, v0
    s_lshl_b32 s96, s79, 13
    s_add_u32 s96, s96, 5275648
    s_lshl_b32 s97, s79, 12
    s_add_u32 s97, s97, 5521408
    v_lshl_add_u32 v23, v0, 7, s97
    s_lshl_b32 s97, s79, 2
    v_add_u32 v17, s97, v5
    s_lshl_b32 s92, s79, 10
    s_add_u32 s92, s92, 147456
    v_add_u32 v20, s92, v22
    v_and_b32 v18, 0x1ff, v22
    s_lshl_b32 s92, s79, 9
    s_add_u32 s92, s92, 155648
    v_add_u32 v18, s92, v18
L_poll_18:
    ds_read_b32 v7, v5 offset:44
    s_waitcnt lgkmcnt(0)
    v_readfirstlane_b32 s98, v7
    s_cmp_ge_u32 s98, 5
    s_cbranch_scc1 L_poll_18_d
    s_sleep 1
    s_add_u32 s100, s100, 1
    s_cmp_lt_u32 s100, 60000
    s_cbranch_scc1 L_poll_18
L_poll_18_d:
    s_mov_b32 exec_lo, 0x5555
    s_mov_b32 exec_hi, 0x0
L_gp_19:
    buffer_load_dword v21, v23, s[64:67], 0 offen sc1
    s_waitcnt vmcnt(0)
    v_cmp_ne_u32 vcc, s71, v21
    s_and_b64 exec, exec, vcc
    s_cbranch_execz L_gp_19_d
    s_sleep 1
    s_add_u32 s100, s100, 1
    s_cmp_lt_u32 s100, 60000
    s_cbranch_scc1 L_gp_19
L_gp_19_d:
    s_mov_b64 exec, -1
    buffer_load_dwordx4 v[24:27], v22, s[64:67], s96 offen offset:0 sc1
    buffer_load_dwordx4 v[28:31], v22, s[64:67], s96 offen offset:1024 sc1
    buffer_load_dwordx4 v[32:35], v22, s[64:67], s96 offen offset:2048 sc1
    buffer_load_dwordx4 v[36:39], v22, s[64:67], s96 offen offset:3072 sc1
    s_mov_b32 exec_lo, 0xffffaaaa
    s_mov_b32 exec_hi, 0
    buffer_load_dword v21, v23, s[64:67], 0 offen sc1
    s_mov_b64 exec, -1
L_poll_20:
    ds_read_b32 v7, v5 offset:4
    s_waitcnt lgkmcnt(0)
    v_readfirstlane_b32 s98, v7
    s_cmp_ge_u32 s98, 4
    s_cbranch_scc1 L_poll_20_d
    s_sleep 1
    s_add_u32 s100, s100, 1
    s_cmp_lt_u32 s100, 60000
    s_cbranch_scc1 L_poll_20
L_poll_20_d:
    ds_read_b128 v[104:107], v20
    ds_read_b128 v[108:111], v20 offset:4096
    s_waitcnt vmcnt(1) lgkmcnt(0)
    v_mfma_f32_32x32x16_bf16 v[120:135], v[24:27], v[104:107], 0
    v_mfma_f32_32x32x16_bf16 v[136:151], v[28:31], v[104:107], 0
    v_mfma_f32_32x32x16_bf16 v[40:55], v[32:35], v[104:107], 0
    v_mfma_f32_32x32x16_bf16 v[56:71], v[36:39], v[104:107], 0
    s_nop 0
    s_nop 0
    s_nop 0
    s_nop 0
    s_nop 0
    s_nop 0
    s_nop 0
    s_nop 0
    s_nop 0
    v_max_f32 v152, v120, v121
    v_max3_f32 v152, v152, v122, v123
    v_max3_f32 v152, v152, v124, v125
    v_max3_f32 v152, v152, v126, v127
    v_max3_f32 v152, v152, v128, v129
    v_max3_f32 v152, v152, v130, v131
    v_max3_f32 v152, v152, v132, v133
    v_max3_f32 v152, v152, v134, v135
    v_max3_f32 v152, v152, v136, v137
    v_max3_f32 v152, v152, v138, v139
    v_max3_f32 v152, v152, v140, v141
    v_max3_f32 v152, v152, v142, v143
    v_max3_f32 v152, v152, v144, v145
    v_max3_f32 v152, v152, v146, v147
    v_max3_f32 v152, v152, v148, v149
    v_max3_f32 v152, v152, v150, v151
    v_max3_f32 v152, v152, v40, v41
    v_max3_f32 v152, v152, v42, v43
    v_max3_f32 v152, v152, v44, v45
    v_max3_f32 v152, v152, v46, v47
    v_max3_f32 v152, v152, v48, v49
    v_max3_f32 v152, v152, v50, v51
    v_max3_f32 v152, v152, v52, v53
    v_max3_f32 v152, v152, v54, v55
    v_max3_f32 v152, v152, v56, v57
    v_max3_f32 v152, v152, v58, v59
    v_max3_f32 v152, v152, v60, v61
    v_max3_f32 v152, v152, v62, v63
    v_max3_f32 v152, v152, v64, v65
    v_max3_f32 v152, v152, v66, v67
    v_max3_f32 v152, v152, v68, v69
    v_max3_f32 v152, v152, v70, v71
    v_mov_b32 v153, v152
    s_nop 0
    s_nop 0
    v_permlane32_swap_b32 v152, v153
    s_nop 0
    v_max_f32 v152, v152, v153
    v_sub_f32 v152, 0xc2c80000, v152
    v_mov_b32 v153, v152
    v_mov_b32 v154, v152
    v_mov_b32 v155, v152
    ds_write_b128 v18, v[152:155] offset:0
    s_cmp_eq_u32 s79, 0
    s_cselect_b32 exec_lo, 1, 0
    s_mov_b32 exec_hi, 0
    ds_write_b32 v5, v6 offset:16
    s_mov_b64 exec, -1
    s_mov_b32 exec_lo, 0xffffaaaa
    s_mov_b32 exec_hi, 0
    s_waitcnt vmcnt(0)
    s_branch L_gp_21_c
L_gp_21:
    buffer_load_dword v21, v23, s[64:67], 0 offen sc1
    s_waitcnt vmcnt(0)
L_gp_21_c:
    v_cmp_ne_u32 vcc, s71, v21
    s_and_b64 exec, exec, vcc
    s_cbranch_execz L_gp_21_d
    s_sleep 1
    s_add_u32 s100, s100, 1
    s_cmp_lt_u32 s100, 60000
    s_cbranch_scc1 L_gp_21
L_gp_21_d:
    s_mov_b64 exec, -1
    s_mov_b64 exec, 1
    ds_add_u32 v17, v6 offset:48
    s_mov_b64 exec, -1
    v_mfma_f32_32x32x16_bf16 v[120:135], v[24:27], v[108:111], 0
    v_mfma_f32_32x32x16_bf16 v[136:151], v[28:31], v[108:111], 0
    v_mfma_f32_32x32x16_bf16 v[40:55], v[32:35], v[108:111], 0
    v_mfma_f32_32x32x16_bf16 v[56:71], v[36:39], v[108:111], 0
    s_nop 0
    s_nop 0
    s_nop 0
    s_nop 0
    s_nop 0
    s_nop 0
    s_nop 0
    s_nop 0
    s_nop 0
    v_max_f32 v156, v120, v121
    v_max3_f32 v156, v156, v122, v123
    v_max3_f32 v156, v156, v124, v125
    v_max3_f32 v156, v156, v126, v127
    v_max3_f32 v156, v156, v128, v129
    v_max3_f32 v156, v156, v130, v131
    v_max3_f32 v156, v156, v132, v133
    v_max3_f32 v156, v156, v134, v135
    v_max3_f32 v156, v156, v136, v137
    v_max3_f32 v156, v156, v138, v139
    v_max3_f32 v156, v156, v140, v141
    v_max3_f32 v156, v156, v142, v143
    v_max3_f32 v156, v156, v144, v145
    v_max3_f32 v156, v156, v146, v147
    v_max3_f32 v156, v156, v148, v149
    v_max3_f32 v156, v156, v150, v151
    v_max3_f32 v156, v156, v40, v41
    v_max3_f32 v156, v156, v42, v43
    v_max3_f32 v156, v156, v44, v45
    v_max3_f32 v156, v156, v46, v47
    v_max3_f32 v156, v156, v48, v49
    v_max3_f32 v156, v156, v50, v51
    v_max3_f32 v156, v156, v52, v53
    v_max3_f32 v156, v156, v54, v55
    v_max3_f32 v156, v156, v56, v57
    v_max3_f32 v156, v156, v58, v59
    v_max3_f32 v156, v156, v60, v61
    v_max3_f32 v156, v156, v62, v63
    v_max3_f32 v156, v156, v64, v65
    v_max3_f32 v156, v156, v66, v67
    v_max3_f32 v156, v156, v68, v69
    v_max3_f32 v156, v156, v70, v71
    v_mov_b32 v157, v156
    s_nop 0
    s_nop 0
    v_permlane32_swap_b32 v156, v157
    s_nop 0
    v_max_f32 v156, v156, v157
    v_sub_f32 v156, 0xc2c80000, v156
    v_mov_b32 v157, v156
    v_mov_b32 v158, v156
    v_mov_b32 v159, v156
    ds_write_b128 v18, v[156:159] offset:2048
    s_mov_b64 exec, 1
    ds_add_u32 v5, v6 offset:4
    s_mov_b64 exec, -1
    v_lshrrev_b32 v20, 3, v0
    v_bfe_u32 v21, v0, 4, 1
    v_lshlrev_b32 v21, 2, v21
    v_and_b32 v22, 7, v0
    v_xor_b32 v21, v21, v22
    v_lshlrev_b32 v21, 4, v21
    v_lshl_add_u32 v20, v20, 10, v21
    v_lshlrev_b32 v21, 7, v0
    s_cmp_eq_u32 s77, 0
    s_cselect_b32 s40, s44, s56
    s_cselect_b32 s41, s45, s57
    s_mov_b32 s42, 0x80000
L_poll_22:
    ds_read_b32 v7, v5 offset:8
    s_waitcnt lgkmcnt(0)
    v_readfirstlane_b32 s98, v7
    s_cmp_ge_u32 s98, 8
    s_cbranch_scc1 L_poll_22_d
    s_sleep 2
    s_add_u32 s100, s100, 1
    s_cmp_lt_u32 s100, 60000
    s_cbranch_scc1 L_poll_22
L_poll_22_d:
    s_add_u32 s93, s83, 0
    s_and_b32 s93, s93, 7
    s_lshl_b32 s94, s93, 7
    s_mul_i32 s93, s93, 196608
    s_add_u32 s93, s93, s82
    s_add_u32 s95, s94, s80
    s_add_u32 m0, s84, 0
    s_add_u32 s92, s95, 0
    buffer_load_dwordx4 v1, s[48:51], s92 offen lds
    s_add_u32 m0, s84, 1024
    s_add_u32 s92, s95, 16384
    buffer_load_dwordx4 v2, s[48:51], s92 offen lds
    s_add_u32 m0, s86, 0
    s_add_u32 s92, s93, 0
    buffer_load_dwordx4 v4, s[52:55], s92 offen lds
    s_add_u32 m0, s86, 1024
    s_add_u32 s92, s93, 24576
    buffer_load_dwordx4 v16, s[52:55], s92 offen lds
    s_add_u32 m0, s86, 8192
    s_add_u32 s92, s93, 1024
    buffer_load_dwordx4 v4, s[52:55], s92 offen lds
    s_add_u32 m0, s86, 9216
    s_add_u32 s92, s93, 25600
    buffer_load_dwordx4 v16, s[52:55], s92 offen lds
    s_add_u32 m0, s86, 16384
    s_add_u32 s92, s93, 2048
    buffer_load_dwordx4 v4, s[52:55], s92 offen lds
    s_add_u32 m0, s86, 17408
    s_add_u32 s92, s93, 26624
    buffer_load_dwordx4 v16, s[52:55], s92 offen lds
    s_add_u32 m0, s85, 0
    s_add_u32 s92, s94, s81
    s_mov_b32 exec_hi, 0
    buffer_load_dwordx4 v3, s[48:51], s92 offen lds
    s_mov_b64 exec, -1
    s_add_u32 s93, s83, 1
    s_and_b32 s93, s93, 7
    s_lshl_b32 s94, s93, 7
    s_mul_i32 s93, s93, 196608
    s_add_u32 s93, s93, s82
    s_add_u32 s95, s94, s80
    s_add_u32 m0, s84, 34816
    s_add_u32 s92, s95, 0
    buffer_load_dwordx4 v1, s[48:51], s92 offen lds
    s_add_u32 m0, s84, 35840
    s_add_u32 s92, s95, 16384
    buffer_load_dwordx4 v2, s[48:51], s92 offen lds
    s_add_u32 m0, s86, 34816
    s_add_u32 s92, s93, 0
    buffer_load_dwordx4 v4, s[52:55], s92 offen lds
    s_add_u32 m0, s86, 35840
    s_add_u32 s92, s93, 24576
    buffer_load_dwordx4 v16, s[52:55], s92 offen lds
    s_add_u32 m0, s86, 43008
    s_add_u32 s92, s93, 1024
    buffer_load_dwordx4 v4, s[52:55], s92 offen lds
    s_add_u32 m0, s86, 44032
    s_add_u32 s92, s93, 25600
    buffer_load_dwordx4 v16, s[52:55], s92 offen lds
    s_add_u32 m0, s86, 51200
    s_add_u32 s92, s93, 2048
    buffer_load_dwordx4 v4, s[52:55], s92 offen lds
    s_add_u32 m0, s86, 52224
    s_add_u32 s92, s93, 26624
    buffer_load_dwordx4 v16, s[52:55], s92 offen lds
    s_add_u32 m0, s85, 34816
    s_add_u32 s92, s94, s81
    s_mov_b32 exec_hi, 0
    buffer_load_dwordx4 v3, s[48:51], s92 offen lds
    s_mov_b64 exec, -1
    s_waitcnt vmcnt(9)
    s_mov_b64 exec, 1
    ds_add_u32 v5, v6 offset:0
    s_mov_b64 exec, -1
L_poll_23:
    ds_read_b32 v7, v5 offset:0
    s_waitcnt lgkmcnt(0)
    v_readfirstlane_b32 s98, v7
    s_cmp_ge_u32 s98, 8
    s_cbranch_scc1 L_poll_23_d
    s_sleep 1
    s_add_u32 s100, s100, 1
    s_cmp_lt_u32 s100, 60000
    s_cbranch_scc1 L_poll_23
L_poll_23_d:
    s_setprio 1
    ds_read_b128 v[104:107], v8 offset:0
    ds_read_b64_tr_b16 v[116:117], v12 offset:0
    ds_read_b64_tr_b16 v[118:119], v12 offset:512
    ds_read_b64_tr_b16 v[120:121], v12 offset:8192
    ds_read_b64_tr_b16 v[122:123], v12 offset:8704
    ds_read_b64_tr_b16 v[124:125], v12 offset:16384
    ds_read_b64_tr_b16 v[126:127], v12 offset:16896
    ds_read_b128 v[112:115], v13 offset:0
    ds_read_b64_tr_b16 v[128:129], v15 offset:8192
    ds_read_b64_tr_b16 v[130:131], v15 offset:8704
    s_waitcnt lgkmcnt(7)
    v_mfma_f32_32x32x16_bf16 v[24:39], v[116:119], v[104:107], 0
    ds_read_b128 v[108:111], v9 offset:0
    ds_read_b64_tr_b16 v[132:133], v12 offset:2048
    ds_read_b64_tr_b16 v[134:135], v12 offset:2560
    s_waitcnt lgkmcnt(8)
    v_mfma_f32_32x32x16_bf16 v[40:55], v[120:123], v[104:107], 0
    ds_read_b64_tr_b16 v[136:137], v12 offset:10240
    ds_read_b64_tr_b16 v[138:139], v12 offset:10752
    s_waitcnt lgkmcnt(8)
    v_mfma_f32_32x32x16_bf16 v[56:71], v[104:107], v[124:127], 0
    ds_read_b64_tr_b16 v[140:141], v12 offset:18432
    ds_read_b64_tr_b16 v[142:143], v12 offset:18944
    s_waitcnt lgkmcnt(7)
    v_mfma_f32_16x16x32_bf16 v[72:75], v[128:131], v[112:115], 0
    ds_read_b64_tr_b16 v[144:145], v15 offset:16384
    ds_read_b64_tr_b16 v[146:147], v15 offset:16896
    s_waitcnt lgkmcnt(6)
    v_mfma_f32_32x32x16_bf16 v[24:39], v[132:135], v[108:111], v[24:39]
    ds_read_b128 v[104:107], v10 offset:0
    ds_read_b64_tr_b16 v[148:149], v12 offset:4096
    ds_read_b64_tr_b16 v[150:151], v12 offset:4608
    s_waitcnt lgkmcnt(7)
    v_mfma_f32_32x32x16_bf16 v[40:55], v[136:139], v[108:111], v[40:55]
    ds_read_b64_tr_b16 v[152:153], v12 offset:12288
    ds_read_b64_tr_b16 v[154:155], v12 offset:12800
    s_waitcnt lgkmcnt(7)
    v_mfma_f32_32x32x16_bf16 v[56:71], v[108:111], v[140:143], v[56:71]
    ds_read_b64_tr_b16 v[156:157], v12 offset:20480
    ds_read_b64_tr_b16 v[158:159], v12 offset:20992
    s_waitcnt lgkmcnt(7)
    v_mfma_f32_16x16x32_bf16 v[76:79], v[112:115], v[144:147], 0
    ds_read_b128 v[112:115], v14 offset:0
    ds_read_b64_tr_b16 v[160:161], v15 offset:12288
    ds_read_b64_tr_b16 v[162:163], v15 offset:12800
    s_waitcnt lgkmcnt(7)
    v_mfma_f32_32x32x16_bf16 v[24:39], v[148:151], v[104:107], v[24:39]
    ds_read_b128 v[108:111], v11 offset:0
    ds_read_b64_tr_b16 v[116:117], v12 offset:6144
    ds_read_b64_tr_b16 v[118:119], v12 offset:6656
    s_waitcnt lgkmcnt(8)
    v_mfma_f32_32x32x16_bf16 v[40:55], v[152:155], v[104:107], v[40:55]
    ds_read_b64_tr_b16 v[120:121], v12 offset:14336
    ds_read_b64_tr_b16 v[122:123], v12 offset:14848
    s_waitcnt lgkmcnt(8)
    v_mfma_f32_32x32x16_bf16 v[56:71], v[104:107], v[156:159], v[56:71]
    ds_read_b64_tr_b16 v[124:125], v12 offset:22528
    ds_read_b64_tr_b16 v[126:127], v12 offset:23040
    s_waitcnt lgkmcnt(7)
    v_mfma_f32_16x16x32_bf16 v[72:75], v[160:163], v[112:115], v[72:75]
    ds_read_b64_tr_b16 v[128:129], v15 offset:20480
    ds_read_b64_tr_b16 v[130:131], v15 offset:20992
    s_waitcnt vmcnt(0)
    s_mov_b64 exec, 1
    ds_add_u32 v5, v6 offset:0
    s_mov_b64 exec, -1
    s_waitcnt lgkmcnt(7)
    v_mfma_f32_32x32x16_bf16 v[24:39], v[116:119], v[108:111], v[24:39]
    s_waitcnt lgkmcnt(5)
    v_mfma_f32_32x32x16_bf16 v[40:55], v[120:123], v[108:111], v[40:55]
L_poll_24:
    ds_read_b32 v7, v5 offset:0
    s_waitcnt lgkmcnt(0)
    v_readfirstlane_b32 s98, v7
    s_cmp_ge_u32 s98, 12
    s_cbranch_scc1 L_poll_24_d
    s_sleep 0
    s_add_u32 s100, s100, 1
    s_cmp_lt_u32 s100, 60000
    s_cbranch_scc1 L_poll_24
L_poll_24_d:
    ds_read_b128 v[104:107], v8 offset:34816
    ds_read_b64_tr_b16 v[132:133], v12 offset:34816
    ds_read_b64_tr_b16 v[134:135], v12 offset:35328
    s_add_u32 s93, s83, 2
    s_and_b32 s93, s93, 7
    s_lshl_b32 s94, s93, 7
    s_mul_i32 s93, s93, 196608
    s_add_u32 s93, s93, s82
    s_add_u32 s95, s94, s80
    s_add_u32 m0, s84, 0
    s_add_u32 s92, s95, 0
    buffer_load_dwordx4 v1, s[48:51], s92 offen lds
    s_add_u32 m0, s84, 1024
    s_add_u32 s92, s95, 16384
    buffer_load_dwordx4 v2, s[48:51], s92 offen lds
    s_add_u32 m0, s86, 0
    s_add_u32 s92, s93, 0
    buffer_load_dwordx4 v4, s[52:55], s92 offen lds
    s_add_u32 m0, s86, 1024
    s_add_u32 s92, s93, 24576
    buffer_load_dwordx4 v16, s[52:55], s92 offen lds
    v_mfma_f32_32x32x16_bf16 v[56:71], v[108:111], v[124:127], v[56:71]
    ds_read_b64_tr_b16 v[136:137], v12 offset:43008
    ds_read_b64_tr_b16 v[138:139], v12 offset:43520
    s_add_u32 m0, s86, 8192
    s_add_u32 s92, s93, 1024
    buffer_load_dwordx4 v4, s[52:55], s92 offen lds
    s_add_u32 m0, s86, 9216
    s_add_u32 s92, s93, 25600
    buffer_load_dwordx4 v16, s[52:55], s92 offen lds
    s_add_u32 m0, s86, 16384
    s_add_u32 s92, s93, 2048
    buffer_load_dwordx4 v4, s[52:55], s92 offen lds
    s_add_u32 m0, s86, 17408
    s_add_u32 s92, s93, 26624
    buffer_load_dwordx4 v16, s[52:55], s92 offen lds
    v_mfma_f32_16x16x32_bf16 v[76:79], v[112:115], v[128:131], v[76:79]
    ds_read_b64_tr_b16 v[140:141], v12 offset:51200
    ds_read_b64_tr_b16 v[142:143], v12 offset:51712
    ds_read_b128 v[112:115], v13 offset:34816
    ds_read_b64_tr_b16 v[144:145], v15 offset:43008
    ds_read_b64_tr_b16 v[146:147], v15 offset:43520
    s_add_u32 m0, s85, 0
    s_add_u32 s92, s94, s81
    s_mov_b32 exec_hi, 0
    buffer_load_dwordx4 v3, s[48:51], s92 offen lds
    s_mov_b64 exec, -1
    s_waitcnt lgkmcnt(7)
    v_mfma_f32_32x32x16_bf16 v[24:39], v[132:135], v[104:107], v[24:39]
    ds_read_b128 v[108:111], v9 offset:34816
    ds_read_b64_tr_b16 v[148:149], v12 offset:36864
    ds_read_b64_tr_b16 v[150:151], v12 offset:37376
    s_waitcnt lgkmcnt(8)
    v_mfma_f32_32x32x16_bf16 v[40:55], v[136:139], v[104:107], v[40:55]
    ds_read_b64_tr_b16 v[152:153], v12 offset:45056
    ds_read_b64_tr_b16 v[154:155], v12 offset:45568
    s_waitcnt lgkmcnt(8)
    v_mfma_f32_32x32x16_bf16 v[56:71], v[104:107], v[140:143], v[56:71]
    ds_read_b64_tr_b16 v[156:157], v12 offset:53248
    ds_read_b64_tr_b16 v[158:159], v12 offset:53760
    s_waitcnt lgkmcnt(7)
    v_mfma_f32_16x16x32_bf16 v[72:75], v[144:147], v[112:115], v[72:75]
    ds_read_b64_tr_b16 v[160:161], v15 offset:51200
    ds_read_b64_tr_b16 v[162:163], v15 offset:51712
    s_waitcnt lgkmcnt(6)
    v_mfma_f32_32x32x16_bf16 v[24:39], v[148:151], v[108:111], v[24:39]
    ds_read_b128 v[104:107], v10 offset:34816
    ds_read_b64_tr_b16 v[116:117], v12 offset:38912
    ds_read_b64_tr_b16 v[118:119], v12 offset:39424
    s_waitcnt lgkmcnt(7)
    v_mfma_f32_32x32x16_bf16 v[40:55], v[152:155], v[108:111], v[40:55]
    ds_read_b64_tr_b16 v[120:121], v12 offset:47104
    ds_read_b64_tr_b16 v[122:123], v12 offset:47616
    s_waitcnt lgkmcnt(7)
    v_mfma_f32_32x32x16_bf16 v[56:71], v[108:111], v[156:159], v[56:71]
    ds_read_b64_tr_b16 v[124:125], v12 offset:55296
    ds_read_b64_tr_b16 v[126:127], v12 offset:55808
    s_waitcnt lgkmcnt(7)
    v_mfma_f32_16x16x32_bf16 v[76:79], v[112:115], v[160:163], v[76:79]
    ds_read_b128 v[112:115], v14 offset:34816
    ds_read_b64_tr_b16 v[128:129], v15 offset:47104
    ds_read_b64_tr_b16 v[130:131], v15 offset:47616
    s_waitcnt lgkmcnt(7)
    v_mfma_f32_32x32x16_bf16 v[24:39], v[116:119], v[104:107], v[24:39]
    ds_read_b128 v[108:111], v11 offset:34816
    ds_read_b64_tr_b16 v[132:133], v12 offset:40960
    ds_read_b64_tr_b16 v[134:135], v12 offset:41472
    s_waitcnt lgkmcnt(8)
    v_mfma_f32_32x32x16_bf16 v[40:55], v[120:123], v[104:107], v[40:55]
    ds_read_b64_tr_b16 v[136:137], v12 offset:49152
    ds_read_b64_tr_b16 v[138:139], v12 offset:49664
    s_waitcnt lgkmcnt(8)
    v_mfma_f32_32x32x16_bf16 v[56:71], v[104:107], v[124:127], v[56:71]
    ds_read_b64_tr_b16 v[140:141], v12 offset:57344
    ds_read_b64_tr_b16 v[142:143], v12 offset:57856
    s_waitcnt lgkmcnt(7)
    v_mfma_f32_16x16x32_bf16 v[72:75], v[128:131], v[112:115], v[72:75]
    ds_read_b64_tr_b16 v[144:145], v15 offset:55296
    ds_read_b64_tr_b16 v[146:147], v15 offset:55808
    s_waitcnt vmcnt(0)
    s_mov_b64 exec, 1
    ds_add_u32 v5, v6 offset:0
    s_mov_b64 exec, -1
    s_waitcnt lgkmcnt(7)
    v_mfma_f32_32x32x16_bf16 v[24:39], v[132:135], v[108:111], v[24:39]
    s_waitcnt lgkmcnt(5)
    v_mfma_f32_32x32x16_bf16 v[40:55], v[136:139], v[108:111], v[40:55]
L_poll_25:
    ds_read_b32 v7, v5 offset:0
    s_waitcnt lgkmcnt(0)
    v_readfirstlane_b32 s98, v7
    s_cmp_ge_u32 s98, 16
    s_cbranch_scc1 L_poll_25_d
    s_sleep 0
    s_add_u32 s100, s100, 1
    s_cmp_lt_u32 s100, 60000
    s_cbranch_scc1 L_poll_25
L_poll_25_d:
    ds_read_b128 v[104:107], v8 offset:0
    ds_read_b64_tr_b16 v[148:149], v12 offset:0
    ds_read_b64_tr_b16 v[150:151], v12 offset:512
    s_add_u32 s93, s83, 3
    s_and_b32 s93, s93, 7
    s_lshl_b32 s94, s93, 7
    s_mul_i32 s93, s93, 196608
    s_add_u32 s93, s93, s82
    s_add_u32 s95, s94, s80
    s_add_u32 m0, s84, 34816
    s_add_u32 s92, s95, 0
    buffer_load_dwordx4 v1, s[48:51], s92 offen lds
    s_add_u32 m0, s84, 35840
    s_add_u32 s92, s95, 16384
    buffer_load_dwordx4 v2, s[48:51], s92 offen lds
    s_add_u32 m0, s86, 34816
    s_add_u32 s92, s93, 0
    buffer_load_dwordx4 v4, s[52:55], s92 offen lds
    s_add_u32 m0, s86, 35840
    s_add_u32 s92, s93, 24576
    buffer_load_dwordx4 v16, s[52:55], s92 offen lds
    v_mfma_f32_32x32x16_bf16 v[56:71], v[108:111], v[140:143], v[56:71]
    ds_read_b64_tr_b16 v[152:153], v12 offset:8192
    ds_read_b64_tr_b16 v[154:155], v12 offset:8704
    s_add_u32 m0, s86, 43008
    s_add_u32 s92, s93, 1024
    buffer_load_dwordx4 v4, s[52:55], s92 offen lds
    s_add_u32 m0, s86, 44032
    s_add_u32 s92, s93, 25600
    buffer_load_dwordx4 v16, s[52:55], s92 offen lds
    s_add_u32 m0, s86, 51200
    s_add_u32 s92, s93, 2048
    buffer_load_dwordx4 v4, s[52:55], s92 offen lds
    s_add_u32 m0, s86, 52224
    s_add_u32 s92, s93, 26624
    buffer_load_dwordx4 v16, s[52:55], s92 offen lds
    v_mfma_f32_16x16x32_bf16 v[76:79], v[112:115], v[144:147], v[76:79]
    ds_read_b64_tr_b16 v[156:157], v12 offset:16384
    ds_read_b64_tr_b16 v[158:159], v12 offset:16896
    ds_read_b128 v[112:115], v13 offset:0
    ds_read_b64_tr_b16 v[160:161], v15 offset:8192
    ds_read_b64_tr_b16 v[162:163], v15 offset:8704
    s_add_u32 m0, s85, 34816
    s_add_u32 s92, s94, s81
    s_mov_b32 exec_hi, 0
    buffer_load_dwordx4 v3, s[48:51], s92 offen lds
    s_mov_b64 exec, -1
    s_waitcnt lgkmcnt(7)
    v_mfma_f32_32x32x16_bf16 v[24:39], v[148:151], v[104:107], v[24:39]
    ds_read_b128 v[108:111], v9 offset:0
    ds_read_b64_tr_b16 v[116:117], v12 offset:2048
    ds_read_b64_tr_b16 v[118:119], v12 offset:2560
    s_waitcnt lgkmcnt(8)
    v_mfma_f32_32x32x16_bf16 v[40:55], v[152:155], v[104:107], v[40:55]
    ds_read_b64_tr_b16 v[120:121], v12 offset:10240
    ds_read_b64_tr_b16 v[122:123], v12 offset:10752
    s_waitcnt lgkmcnt(8)
    v_mfma_f32_32x32x16_bf16 v[56:71], v[104:107], v[156:159], v[56:71]
    ds_read_b64_tr_b16 v[124:125], v12 offset:18432
    ds_read_b64_tr_b16 v[126:127], v12 offset:18944
    s_waitcnt lgkmcnt(7)
    v_mfma_f32_16x16x32_bf16 v[72:75], v[160:163], v[112:115], v[72:75]
    ds_read_b64_tr_b16 v[128:129], v15 offset:16384
    ds_read_b64_tr_b16 v[130:131], v15 offset:16896
    s_waitcnt lgkmcnt(6)
    v_mfma_f32_32x32x16_bf16 v[24:39], v[116:119], v[108:111], v[24:39]
    ds_read_b128 v[104:107], v10 offset:0
    ds_read_b64_tr_b16 v[132:133], v12 offset:4096
    ds_read_b64_tr_b16 v[134:135], v12 offset:4608
    s_waitcnt lgkmcnt(7)
    v_mfma_f32_32x32x16_bf16 v[40:55], v[120:123], v[108:111], v[40:55]
    ds_read_b64_tr_b16 v[136:137], v12 offset:12288
    ds_read_b64_tr_b16 v[138:139], v12 offset:12800
    s_waitcnt lgkmcnt(7)
    v_mfma_f32_32x32x16_bf16 v[56:71], v[108:111], v[124:127], v[56:71]
    ds_read_b64_tr_b16 v[140:141], v12 offset:20480
    ds_read_b64_tr_b16 v[142:143], v12 offset:20992
    s_waitcnt lgkmcnt(7)
    v_mfma_f32_16x16x32_bf16 v[76:79], v[112:115], v[128:131], v[76:79]
    ds_read_b128 v[112:115], v14 offset:0
    ds_read_b64_tr_b16 v[144:145], v15 offset:12288
    ds_read_b64_tr_b16 v[146:147], v15 offset:12800
    s_waitcnt lgkmcnt(7)
    v_mfma_f32_32x32x16_bf16 v[24:39], v[132:135], v[104:107], v[24:39]
    ds_read_b128 v[108:111], v11 offset:0
    ds_read_b64_tr_b16 v[148:149], v12 offset:6144
    ds_read_b64_tr_b16 v[150:151], v12 offset:6656
    s_waitcnt lgkmcnt(8)
    v_mfma_f32_32x32x16_bf16 v[40:55], v[136:139], v[104:107], v[40:55]
    ds_read_b64_tr_b16 v[152:153], v12 offset:14336
    ds_read_b64_tr_b16 v[154:155], v12 offset:14848
    s_waitcnt lgkmcnt(8)
    v_mfma_f32_32x32x16_bf16 v[56:71], v[104:107], v[140:143], v[56:71]
    ds_read_b64_tr_b16 v[156:157], v12 offset:22528
    ds_read_b64_tr_b16 v[158:159], v12 offset:23040
    s_waitcnt lgkmcnt(7)
    v_mfma_f32_16x16x32_bf16 v[72:75], v[144:147], v[112:115], v[72:75]
    ds_read_b64_tr_b16 v[160:161], v15 offset:20480
    ds_read_b64_tr_b16 v[162:163], v15 offset:20992
    s_waitcnt vmcnt(0)
    s_mov_b64 exec, 1
    ds_add_u32 v5, v6 offset:0
    s_mov_b64 exec, -1
    s_waitcnt lgkmcnt(7)
    v_mfma_f32_32x32x16_bf16 v[24:39], v[148:151], v[108:111], v[24:39]
    s_waitcnt lgkmcnt(5)
    v_mfma_f32_32x32x16_bf16 v[40:55], v[152:155], v[108:111], v[40:55]
L_poll_26:
    ds_read_b32 v7, v5 offset:0
    s_waitcnt lgkmcnt(0)
    v_readfirstlane_b32 s98, v7
    s_cmp_ge_u32 s98, 20
    s_cbranch_scc1 L_poll_26_d
    s_sleep 0
    s_add_u32 s100, s100, 1
    s_cmp_lt_u32 s100, 60000
    s_cbranch_scc1 L_poll_26
L_poll_26_d:
    ds_read_b128 v[104:107], v8 offset:34816
    ds_read_b64_tr_b16 v[116:117], v12 offset:34816
    ds_read_b64_tr_b16 v[118:119], v12 offset:35328
    s_add_u32 s93, s83, 4
    s_and_b32 s93, s93, 7
    s_lshl_b32 s94, s93, 7
    s_mul_i32 s93, s93, 196608
    s_add_u32 s93, s93, s82
    s_add_u32 s95, s94, s80
    s_add_u32 m0, s84, 0
    s_add_u32 s92, s95, 0
    buffer_load_dwordx4 v1, s[48:51], s92 offen lds
    s_add_u32 m0, s84, 1024
    s_add_u32 s92, s95, 16384
    buffer_load_dwordx4 v2, s[48:51], s92 offen lds
    s_add_u32 m0, s86, 0
    s_add_u32 s92, s93, 0
    buffer_load_dwordx4 v4, s[52:55], s92 offen lds
    s_add_u32 m0, s86, 1024
    s_add_u32 s92, s93, 24576
    buffer_load_dwordx4 v16, s[52:55], s92 offen lds
    v_mfma_f32_32x32x16_bf16 v[56:71], v[108:111], v[156:159], v[56:71]
    ds_read_b64_tr_b16 v[120:121], v12 offset:43008
    ds_read_b64_tr_b16 v[122:123], v12 offset:43520
    s_add_u32 m0, s86, 8192
    s_add_u32 s92, s93, 1024
    buffer_load_dwordx4 v4, s[52:55], s92 offen lds
    s_add_u32 m0, s86, 9216
    s_add_u32 s92, s93, 25600
    buffer_load_dwordx4 v16, s[52:55], s92 offen lds
    s_add_u32 m0, s86, 16384
    s_add_u32 s92, s93, 2048
    buffer_load_dwordx4 v4, s[52:55], s92 offen lds
    s_add_u32 m0, s86, 17408
    s_add_u32 s92, s93, 26624
    buffer_load_dwordx4 v16, s[52:55], s92 offen lds
    v_mfma_f32_16x16x32_bf16 v[76:79], v[112:115], v[160:163], v[76:79]
    ds_read_b64_tr_b16 v[124:125], v12 offset:51200
    ds_read_b64_tr_b16 v[126:127], v12 offset:51712
    ds_read_b128 v[112:115], v13 offset:34816
    ds_read_b64_tr_b16 v[128:129], v15 offset:43008
    ds_read_b64_tr_b16 v[130:131], v15 offset:43520
    s_add_u32 m0, s85, 0
    s_add_u32 s92, s94, s81
    s_mov_b32 exec_hi, 0
    buffer_load_dwordx4 v3, s[48:51], s92 offen lds
    s_mov_b64 exec, -1
    s_and_b32 s92, s101, 31
    s_lshl_b32 s92, s92, 2
    s_add_u32 s92, s92, s79
    s_lshl_b32 s92, s92, 12
    s_mov_b32 exec_hi, 0
    buffer_load_dword v22, v21, s[56:59], s92 offen
    s_mov_b64 exec, -1
    s_waitcnt lgkmcnt(7)
    v_mfma_f32_32x32x16_bf16 v[24:39], v[116:119], v[104:107], v[24:39]
    ds_read_b128 v[108:111], v9 offset:34816
    ds_read_b64_tr_b16 v[132:133], v12 offset:36864
    ds_read_b64_tr_b16 v[134:135], v12 offset:37376
    s_waitcnt lgkmcnt(8)
    v_mfma_f32_32x32x16_bf16 v[40:55], v[120:123], v[104:107], v[40:55]
    ds_read_b64_tr_b16 v[136:137], v12 offset:45056
    ds_read_b64_tr_b16 v[138:139], v12 offset:45568
    s_waitcnt lgkmcnt(8)
    v_mfma_f32_32x32x16_bf16 v[56:71], v[104:107], v[124:127], v[56:71]
    ds_read_b64_tr_b16 v[140:141], v12 offset:53248
    ds_read_b64_tr_b16 v[142:143], v12 offset:53760
    s_waitcnt lgkmcnt(7)
    v_mfma_f32_16x16x32_bf16 v[72:75], v[128:131], v[112:115], v[72:75]
    ds_read_b64_tr_b16 v[144:145], v15 offset:51200
    ds_read_b64_tr_b16 v[146:147], v15 offset:51712
    s_waitcnt lgkmcnt(6)
    v_mfma_f32_32x32x16_bf16 v[24:39], v[132:135], v[108:111], v[24:39]
    ds_read_b128 v[104:107], v10 offset:34816
    ds_read_b64_tr_b16 v[148:149], v12 offset:38912
    ds_read_b64_tr_b16 v[150:151], v12 offset:39424
    s_waitcnt lgkmcnt(7)
    v_mfma_f32_32x32x16_bf16 v[40:55], v[136:139], v[108:111], v[40:55]
    ds_read_b64_tr_b16 v[152:153], v12 offset:47104
    ds_read_b64_tr_b16 v[154:155], v12 offset:47616
    s_waitcnt lgkmcnt(7)
    v_mfma_f32_32x32x16_bf16 v[56:71], v[108:111], v[140:143], v[56:71]
    ds_read_b64_tr_b16 v[156:157], v12 offset:55296
    ds_read_b64_tr_b16 v[158:159], v12 offset:55808
    s_waitcnt lgkmcnt(7)
    v_mfma_f32_16x16x32_bf16 v[76:79], v[112:115], v[144:147], v[76:79]
    ds_read_b128 v[112:115], v14 offset:34816
    ds_read_b64_tr_b16 v[160:161], v15 offset:47104
    ds_read_b64_tr_b16 v[162:163], v15 offset:47616
    s_waitcnt lgkmcnt(7)
    v_mfma_f32_32x32x16_bf16 v[24:39], v[148:151], v[104:107], v[24:39]
    ds_read_b128 v[108:111], v11 offset:34816
    ds_read_b64_tr_b16 v[116:117], v12 offset:40960
    ds_read_b64_tr_b16 v[118:119], v12 offset:41472
    s_waitcnt lgkmcnt(8)
    v_mfma_f32_32x32x16_bf16 v[40:55], v[152:155], v[104:107], v[40:55]
    ds_read_b64_tr_b16 v[120:121], v12 offset:49152
    ds_read_b64_tr_b16 v[122:123], v12 offset:49664
    s_waitcnt lgkmcnt(8)
    v_mfma_f32_32x32x16_bf16 v[56:71], v[104:107], v[156:159], v[56:71]
    ds_read_b64_tr_b16 v[124:125], v12 offset:57344
    ds_read_b64_tr_b16 v[126:127], v12 offset:57856
    s_waitcnt lgkmcnt(7)
    v_mfma_f32_16x16x32_bf16 v[72:75], v[160:163], v[112:115], v[72:75]
    ds_read_b64_tr_b16 v[128:129], v15 offset:55296
    ds_read_b64_tr_b16 v[130:131], v15 offset:55808
    s_waitcnt vmcnt(1)
    s_mov_b64 exec, 1
    ds_add_u32 v5, v6 offset:0
    s_mov_b64 exec, -1
    s_waitcnt lgkmcnt(7)
    v_mfma_f32_32x32x16_bf16 v[24:39], v[116:119], v[108:111], v[24:39]
    s_waitcnt lgkmcnt(5)
    v_mfma_f32_32x32x16_bf16 v[40:55], v[120:123], v[108:111], v[40:55]
L_poll_27:
    ds_read_b32 v7, v5 offset:0
    s_waitcnt lgkmcnt(0)
    v_readfirstlane_b32 s98, v7
    s_cmp_ge_u32 s98, 24
    s_cbranch_scc1 L_poll_27_d
    s_sleep 0
    s_add_u32 s100, s100, 1
    s_cmp_lt_u32 s100, 60000
    s_cbranch_scc1 L_poll_27
L_poll_27_d:
    ds_read_b128 v[104:107], v8 offset:0
    ds_read_b64_tr_b16 v[132:133], v12 offset:0
    ds_read_b64_tr_b16 v[134:135], v12 offset:512
    s_add_u32 s93, s83, 5
    s_and_b32 s93, s93, 7
    s_lshl_b32 s94, s93, 7
    s_mul_i32 s93, s93, 196608
    s_add_u32 s93, s93, s82
    s_add_u32 s95, s94, s80
    s_add_u32 m0, s84, 34816
    s_add_u32 s92, s95, 0
    buffer_load_dwordx4 v1, s[48:51], s92 offen lds
    s_add_u32 m0, s84, 35840
    s_add_u32 s92, s95, 16384
    buffer_load_dwordx4 v2, s[48:51], s92 offen lds
    s_add_u32 m0, s86, 34816
    s_add_u32 s92, s93, 0
    buffer_load_dwordx4 v4, s[52:55], s92 offen lds
    s_add_u32 m0, s86, 35840
    s_add_u32 s92, s93, 24576
    buffer_load_dwordx4 v16, s[52:55], s92 offen lds
    v_mfma_f32_32x32x16_bf16 v[56:71], v[108:111], v[124:127], v[56:71]
    ds_read_b64_tr_b16 v[136:137], v12 offset:8192
    ds_read_b64_tr_b16 v[138:139], v12 offset:8704
    s_add_u32 m0, s86, 43008
    s_add_u32 s92, s93, 1024
    buffer_load_dwordx4 v4, s[52:55], s92 offen lds
    s_add_u32 m0, s86, 44032
    s_add_u32 s92, s93, 25600
    buffer_load_dwordx4 v16, s[52:55], s92 offen lds
    s_add_u32 m0, s86, 51200
    s_add_u32 s92, s93, 2048
    buffer_load_dwordx4 v4, s[52:55], s92 offen lds
    s_add_u32 m0, s86, 52224
    s_add_u32 s92, s93, 26624
    buffer_load_dwordx4 v16, s[52:55], s92 offen lds
    v_mfma_f32_16x16x32_bf16 v[76:79], v[112:115], v[128:131], v[76:79]
    ds_read_b64_tr_b16 v[140:141], v12 offset:16384
    ds_read_b64_tr_b16 v[142:143], v12 offset:16896
    ds_read_b128 v[112:115], v13 offset:0
    ds_read_b64_tr_b16 v[144:145], v15 offset:8192
    ds_read_b64_tr_b16 v[146:147], v15 offset:8704
    s_add_u32 m0, s85, 34816
    s_add_u32 s92, s94, s81
    s_mov_b32 exec_hi, 0
    buffer_load_dwordx4 v3, s[48:51], s92 offen lds
    s_mov_b64 exec, -1
    s_and_b32 s92, s101, 31
    s_lshl_b32 s92, s92, 2
    s_add_u32 s92, s92, s79
    s_lshl_b32 s92, s92, 12
    s_mov_b32 exec_hi, 0
    buffer_load_dword v22, v21, s[44:47], s92 offen
    s_mov_b64 exec, -1
    s_waitcnt lgkmcnt(7)
    v_mfma_f32_32x32x16_bf16 v[24:39], v[132:135], v[104:107], v[24:39]
    ds_read_b128 v[108:111], v9 offset:0
    ds_read_b64_tr_b16 v[148:149], v12 offset:2048
    ds_read_b64_tr_b16 v[150:151], v12 offset:2560
    s_waitcnt lgkmcnt(8)
    v_mfma_f32_32x32x16_bf16 v[40:55], v[136:139], v[104:107], v[40:55]
    ds_read_b64_tr_b16 v[152:153], v12 offset:10240
    ds_read_b64_tr_b16 v[154:155], v12 offset:10752
    s_waitcnt lgkmcnt(8)
    v_mfma_f32_32x32x16_bf16 v[56:71], v[104:107], v[140:143], v[56:71]
    ds_read_b64_tr_b16 v[156:157], v12 offset:18432
    ds_read_b64_tr_b16 v[158:159], v12 offset:18944
    s_waitcnt lgkmcnt(7)
    v_mfma_f32_16x16x32_bf16 v[72:75], v[144:147], v[112:115], v[72:75]
    ds_read_b64_tr_b16 v[160:161], v15 offset:16384
    ds_read_b64_tr_b16 v[162:163], v15 offset:16896
    s_waitcnt lgkmcnt(6)
    v_mfma_f32_32x32x16_bf16 v[24:39], v[148:151], v[108:111], v[24:39]
    ds_read_b128 v[104:107], v10 offset:0
    ds_read_b64_tr_b16 v[116:117], v12 offset:4096
    ds_read_b64_tr_b16 v[118:119], v12 offset:4608
    s_waitcnt lgkmcnt(7)
    v_mfma_f32_32x32x16_bf16 v[40:55], v[152:155], v[108:111], v[40:55]
    ds_read_b64_tr_b16 v[120:121], v12 offset:12288
    ds_read_b64_tr_b16 v[122:123], v12 offset:12800
    s_waitcnt lgkmcnt(7)
    v_mfma_f32_32x32x16_bf16 v[56:71], v[108:111], v[156:159], v[56:71]
    ds_read_b64_tr_b16 v[124:125], v12 offset:20480
    ds_read_b64_tr_b16 v[126:127], v12 offset:20992
    s_waitcnt lgkmcnt(7)
    v_mfma_f32_16x16x32_bf16 v[76:79], v[112:115], v[160:163], v[76:79]
    ds_read_b128 v[112:115], v14 offset:0
    ds_read_b64_tr_b16 v[128:129], v15 offset:12288
    ds_read_b64_tr_b16 v[130:131], v15 offset:12800
    s_waitcnt lgkmcnt(7)
    v_mfma_f32_32x32x16_bf16 v[24:39], v[116:119], v[104:107], v[24:39]
    ds_read_b128 v[108:111], v11 offset:0
    ds_read_b64_tr_b16 v[132:133], v12 offset:6144
    ds_read_b64_tr_b16 v[134:135], v12 offset:6656
    s_waitcnt lgkmcnt(8)
    v_mfma_f32_32x32x16_bf16 v[40:55], v[120:123], v[104:107], v[40:55]
    ds_read_b64_tr_b16 v[136:137], v12 offset:14336
    ds_read_b64_tr_b16 v[138:139], v12 offset:14848
    s_waitcnt lgkmcnt(8)
    v_mfma_f32_32x32x16_bf16 v[56:71], v[104:107], v[124:127], v[56:71]
    ds_read_b64_tr_b16 v[140:141], v12 offset:22528
    ds_read_b64_tr_b16 v[142:143], v12 offset:23040
    s_waitcnt lgkmcnt(7)
    v_mfma_f32_16x16x32_bf16 v[72:75], v[128:131], v[112:115], v[72:75]
    ds_read_b64_tr_b16 v[144:145], v15 offset:20480
    ds_read_b64_tr_b16 v[146:147], v15 offset:20992
    s_waitcnt vmcnt(1)
    s_mov_b64 exec, 1
    ds_add_u32 v5, v6 offset:0
    s_mov_b64 exec, -1
    s_waitcnt lgkmcnt(7)
    v_mfma_f32_32x32x16_bf16 v[24:39], v[132:135], v[108:111], v[24:39]
    s_waitcnt lgkmcnt(5)
    v_mfma_f32_32x32x16_bf16 v[40:55], v[136:139], v[108:111], v[40:55]
L_poll_28:
    ds_read_b32 v7, v5 offset:0
    s_waitcnt lgkmcnt(0)
    v_readfirstlane_b32 s98, v7
    s_cmp_ge_u32 s98, 28
    s_cbranch_scc1 L_poll_28_d
    s_sleep 0
    s_add_u32 s100, s100, 1
    s_cmp_lt_u32 s100, 60000
    s_cbranch_scc1 L_poll_28
L_poll_28_d:
    ds_read_b128 v[104:107], v8 offset:34816
    ds_read_b64_tr_b16 v[148:149], v12 offset:34816
    ds_read_b64_tr_b16 v[150:151], v12 offset:35328
    s_add_u32 s93, s83, 6
    s_and_b32 s93, s93, 7
    s_lshl_b32 s94, s93, 7
    s_mul_i32 s93, s93, 196608
    s_add_u32 s93, s93, s82
    s_add_u32 s95, s94, s80
    s_add_u32 m0, s84, 0
    s_add_u32 s92, s95, 0
    buffer_load_dwordx4 v1, s[48:51], s92 offen lds
    s_add_u32 m0, s84, 1024
    s_add_u32 s92, s95, 16384
    buffer_load_dwordx4 v2, s[48:51], s92 offen lds
    s_add_u32 m0, s86, 0
    s_add_u32 s92, s93, 0
    buffer_load_dwordx4 v4, s[52:55], s92 offen lds
    s_add_u32 m0, s86, 1024
    s_add_u32 s92, s93, 24576
    buffer_load_dwordx4 v16, s[52:55], s92 offen lds
    v_mfma_f32_32x32x16_bf16 v[56:71], v[108:111], v[140:143], v[56:71]
    ds_read_b64_tr_b16 v[152:153], v12 offset:43008
    ds_read_b64_tr_b16 v[154:155], v12 offset:43520
    s_add_u32 m0, s86, 8192
    s_add_u32 s92, s93, 1024
    buffer_load_dwordx4 v4, s[52:55], s92 offen lds
    s_add_u32 m0, s86, 9216
    s_add_u32 s92, s93, 25600
    buffer_load_dwordx4 v16, s[52:55], s92 offen lds
    s_add_u32 m0, s86, 16384
    s_add_u32 s92, s93, 2048
    buffer_load_dwordx4 v4, s[52:55], s92 offen lds
    s_add_u32 m0, s86, 17408
    s_add_u32 s92, s93, 26624
    buffer_load_dwordx4 v16, s[52:55], s92 offen lds
    v_mfma_f32_16x16x32_bf16 v[76:79], v[112:115], v[144:147], v[76:79]
    ds_read_b64_tr_b16 v[156:157], v12 offset:51200
    ds_read_b64_tr_b16 v[158:159], v12 offset:51712
    ds_read_b128 v[112:115], v13 offset:34816
    ds_read_b64_tr_b16 v[160:161], v15 offset:43008
    ds_read_b64_tr_b16 v[162:163], v15 offset:43520
    s_add_u32 m0, s85, 0
    s_add_u32 s92, s94, s81
    s_mov_b32 exec_hi, 0
    buffer_load_dwordx4 v3, s[48:51], s92 offen lds
    s_mov_b64 exec, -1
    s_waitcnt lgkmcnt(7)
    v_mfma_f32_32x32x16_bf16 v[24:39], v[148:151], v[104:107], v[24:39]
    ds_read_b128 v[108:111], v9 offset:34816
    ds_read_b64_tr_b16 v[116:117], v12 offset:36864
    ds_read_b64_tr_b16 v[118:119], v12 offset:37376
    s_waitcnt lgkmcnt(8)
    v_mfma_f32_32x32x16_bf16 v[40:55], v[152:155], v[104:107], v[40:55]
    ds_read_b64_tr_b16 v[120:121], v12 offset:45056
    ds_read_b64_tr_b16 v[122:123], v12 offset:45568
    s_waitcnt lgkmcnt(8)
    v_mfma_f32_32x32x16_bf16 v[56:71], v[104:107], v[156:159], v[56:71]
    ds_read_b64_tr_b16 v[124:125], v12 offset:53248
    ds_read_b64_tr_b16 v[126:127], v12 offset:53760
    s_waitcnt lgkmcnt(7)
    v_mfma_f32_16x16x32_bf16 v[72:75], v[160:163], v[112:115], v[72:75]
    ds_read_b64_tr_b16 v[128:129], v15 offset:51200
    ds_read_b64_tr_b16 v[130:131], v15 offset:51712
    s_waitcnt lgkmcnt(6)
    v_mfma_f32_32x32x16_bf16 v[24:39], v[116:119], v[108:111], v[24:39]
    ds_read_b128 v[104:107], v10 offset:34816
    ds_read_b64_tr_b16 v[132:133], v12 offset:38912
    ds_read_b64_tr_b16 v[134:135], v12 offset:39424
    s_waitcnt lgkmcnt(7)
    v_mfma_f32_32x32x16_bf16 v[40:55], v[120:123], v[108:111], v[40:55]
    ds_read_b64_tr_b16 v[136:137], v12 offset:47104
    ds_read_b64_tr_b16 v[138:139], v12 offset:47616
    s_waitcnt lgkmcnt(7)
    v_mfma_f32_32x32x16_bf16 v[56:71], v[108:111], v[124:127], v[56:71]
    ds_read_b64_tr_b16 v[140:141], v12 offset:55296
    ds_read_b64_tr_b16 v[142:143], v12 offset:55808
    s_waitcnt lgkmcnt(7)
    v_mfma_f32_16x16x32_bf16 v[76:79], v[112:115], v[128:131], v[76:79]
    ds_read_b128 v[112:115], v14 offset:34816
    ds_read_b64_tr_b16 v[144:145], v15 offset:47104
    ds_read_b64_tr_b16 v[146:147], v15 offset:47616
    s_waitcnt lgkmcnt(7)
    v_mfma_f32_32x32x16_bf16 v[24:39], v[132:135], v[104:107], v[24:39]
    ds_read_b128 v[108:111], v11 offset:34816
    ds_read_b64_tr_b16 v[148:149], v12 offset:40960
    ds_read_b64_tr_b16 v[150:151], v12 offset:41472
    s_waitcnt lgkmcnt(8)
    v_mfma_f32_32x32x16_bf16 v[40:55], v[136:139], v[104:107], v[40:55]
    ds_read_b64_tr_b16 v[152:153], v12 offset:49152
    ds_read_b64_tr_b16 v[154:155], v12 offset:49664
    s_waitcnt lgkmcnt(8)
    v_mfma_f32_32x32x16_bf16 v[56:71], v[104:107], v[140:143], v[56:71]
    ds_read_b64_tr_b16 v[156:157], v12 offset:57344
    ds_read_b64_tr_b16 v[158:159], v12 offset:57856
    s_waitcnt lgkmcnt(7)
    v_mfma_f32_16x16x32_bf16 v[72:75], v[144:147], v[112:115], v[72:75]
    ds_read_b64_tr_b16 v[160:161], v15 offset:55296
    ds_read_b64_tr_b16 v[162:163], v15 offset:55808
    s_waitcnt vmcnt(0)
    s_mov_b64 exec, 1
    ds_add_u32 v5, v6 offset:0
    s_mov_b64 exec, -1
    s_waitcnt lgkmcnt(7)
    v_mfma_f32_32x32x16_bf16 v[24:39], v[148:151], v[108:111], v[24:39]
    s_waitcnt lgkmcnt(5)
    v_mfma_f32_32x32x16_bf16 v[40:55], v[152:155], v[108:111], v[40:55]
L_poll_29:
    ds_read_b32 v7, v5 offset:0
    s_waitcnt lgkmcnt(0)
    v_readfirstlane_b32 s98, v7
    s_cmp_ge_u32 s98, 32
    s_cbranch_scc1 L_poll_29_d
    s_sleep 0
    s_add_u32 s100, s100, 1
    s_cmp_lt_u32 s100, 60000
    s_cbranch_scc1 L_poll_29
L_poll_29_d:
    ds_read_b128 v[104:107], v8 offset:0
    ds_read_b64_tr_b16 v[116:117], v12 offset:0
    ds_read_b64_tr_b16 v[118:119], v12 offset:512
    s_add_u32 s93, s83, 7
    s_and_b32 s93, s93, 7
    s_lshl_b32 s94, s93, 7
    s_mul_i32 s93, s93, 196608
    s_add_u32 s93, s93, s82
    s_add_u32 s95, s94, s80
    s_add_u32 m0, s84, 34816
    s_add_u32 s92, s95, 0
    buffer_load_dwordx4 v1, s[48:51], s92 offen lds
    s_add_u32 m0, s84, 35840
    s_add_u32 s92, s95, 16384
    buffer_load_dwordx4 v2, s[48:51], s92 offen lds
    s_add_u32 m0, s86, 34816
    s_add_u32 s92, s93, 0
    buffer_load_dwordx4 v4, s[52:55], s92 offen lds
    s_add_u32 m0, s86, 35840
    s_add_u32 s92, s93, 24576
    buffer_load_dwordx4 v16, s[52:55], s92 offen lds
    v_mfma_f32_32x32x16_bf16 v[56:71], v[108:111], v[156:159], v[56:71]
    ds_read_b64_tr_b16 v[120:121], v12 offset:8192
    ds_read_b64_tr_b16 v[122:123], v12 offset:8704
    s_add_u32 m0, s86, 43008
    s_add_u32 s92, s93, 1024
    buffer_load_dwordx4 v4, s[52:55], s92 offen lds
    s_add_u32 m0, s86, 44032
    s_add_u32 s92, s93, 25600
    buffer_load_dwordx4 v16, s[52:55], s92 offen lds
    s_add_u32 m0, s86, 51200
    s_add_u32 s92, s93, 2048
    buffer_load_dwordx4 v4, s[52:55], s92 offen lds
    s_add_u32 m0, s86, 52224
    s_add_u32 s92, s93, 26624
    buffer_load_dwordx4 v16, s[52:55], s92 offen lds
    v_mfma_f32_16x16x32_bf16 v[76:79], v[112:115], v[160:163], v[76:79]
    ds_read_b64_tr_b16 v[124:125], v12 offset:16384
    ds_read_b64_tr_b16 v[126:127], v12 offset:16896
    ds_read_b128 v[112:115], v13 offset:0
    ds_read_b64_tr_b16 v[128:129], v15 offset:8192
    ds_read_b64_tr_b16 v[130:131], v15 offset:8704
    s_add_u32 m0, s85, 34816
    s_add_u32 s92, s94, s81
    s_mov_b32 exec_hi, 0
    buffer_load_dwordx4 v3, s[48:51], s92 offen lds
    s_mov_b64 exec, -1
    s_waitcnt lgkmcnt(7)
    v_mfma_f32_32x32x16_bf16 v[24:39], v[116:119], v[104:107], v[24:39]
    ds_read_b128 v[108:111], v9 offset:0
    ds_read_b64_tr_b16 v[132:133], v12 offset:2048
    ds_read_b64_tr_b16 v[134:135], v12 offset:2560
    s_waitcnt lgkmcnt(8)
    v_mfma_f32_32x32x16_bf16 v[40:55], v[120:123], v[104:107], v[40:55]
    ds_read_b64_tr_b16 v[136:137], v12 offset:10240
    ds_read_b64_tr_b16 v[138:139], v12 offset:10752
    s_waitcnt lgkmcnt(8)
    v_mfma_f32_32x32x16_bf16 v[56:71], v[104:107], v[124:127], v[56:71]
    ds_read_b64_tr_b16 v[140:141], v12 offset:18432
    ds_read_b64_tr_b16 v[142:143], v12 offset:18944
    s_waitcnt lgkmcnt(7)
    v_mfma_f32_16x16x32_bf16 v[72:75], v[128:131], v[112:115], v[72:75]
    ds_read_b64_tr_b16 v[144:145], v15 offset:16384
    ds_read_b64_tr_b16 v[146:147], v15 offset:16896
    s_waitcnt lgkmcnt(6)
    v_mfma_f32_32x32x16_bf16 v[24:39], v[132:135], v[108:111], v[24:39]
    ds_read_b128 v[104:107], v10 offset:0
    ds_read_b64_tr_b16 v[148:149], v12 offset:4096
    ds_read_b64_tr_b16 v[150:151], v12 offset:4608
    s_waitcnt lgkmcnt(7)
    v_mfma_f32_32x32x16_bf16 v[40:55], v[136:139], v[108:111], v[40:55]
    ds_read_b64_tr_b16 v[152:153], v12 offset:12288
    ds_read_b64_tr_b16 v[154:155], v12 offset:12800
    s_waitcnt lgkmcnt(7)
    v_mfma_f32_32x32x16_bf16 v[56:71], v[108:111], v[140:143], v[56:71]
    ds_read_b64_tr_b16 v[156:157], v12 offset:20480
    ds_read_b64_tr_b16 v[158:159], v12 offset:20992
    s_waitcnt lgkmcnt(7)
    v_mfma_f32_16x16x32_bf16 v[76:79], v[112:115], v[144:147], v[76:79]
    ds_read_b128 v[112:115], v14 offset:0
    ds_read_b64_tr_b16 v[160:161], v15 offset:12288
    ds_read_b64_tr_b16 v[162:163], v15 offset:12800
    s_waitcnt lgkmcnt(7)
    v_mfma_f32_32x32x16_bf16 v[24:39], v[148:151], v[104:107], v[24:39]
    ds_read_b128 v[108:111], v11 offset:0
    ds_read_b64_tr_b16 v[116:117], v12 offset:6144
    ds_read_b64_tr_b16 v[118:119], v12 offset:6656
    s_waitcnt lgkmcnt(8)
    v_mfma_f32_32x32x16_bf16 v[40:55], v[152:155], v[104:107], v[40:55]
    ds_read_b64_tr_b16 v[120:121], v12 offset:14336
    ds_read_b64_tr_b16 v[122:123], v12 offset:14848
    s_waitcnt lgkmcnt(8)
    v_mfma_f32_32x32x16_bf16 v[56:71], v[104:107], v[156:159], v[56:71]
    ds_read_b64_tr_b16 v[124:125], v12 offset:22528
    ds_read_b64_tr_b16 v[126:127], v12 offset:23040
    s_waitcnt lgkmcnt(7)
    v_mfma_f32_16x16x32_bf16 v[72:75], v[160:163], v[112:115], v[72:75]
    ds_read_b64_tr_b16 v[128:129], v15 offset:20480
    ds_read_b64_tr_b16 v[130:131], v15 offset:20992
    s_waitcnt vmcnt(0)
    s_mov_b64 exec, 1
    ds_add_u32 v5, v6 offset:0
    s_mov_b64 exec, -1
    s_waitcnt lgkmcnt(7)
    v_mfma_f32_32x32x16_bf16 v[24:39], v[116:119], v[108:111], v[24:39]
    s_waitcnt lgkmcnt(5)
    v_mfma_f32_32x32x16_bf16 v[40:55], v[120:123], v[108:111], v[40:55]
L_poll_30:
    ds_read_b32 v7, v5 offset:0
    s_waitcnt lgkmcnt(0)
    v_readfirstlane_b32 s98, v7
    s_cmp_ge_u32 s98, 36
    s_cbranch_scc1 L_poll_30_d
    s_sleep 0
    s_add_u32 s100, s100, 1
    s_cmp_lt_u32 s100, 60000
    s_cbranch_scc1 L_poll_30
L_poll_30_d:
    ds_read_b128 v[104:107], v8 offset:34816
    ds_read_b64_tr_b16 v[132:133], v12 offset:34816
    ds_read_b64_tr_b16 v[134:135], v12 offset:35328
    s_lshl_b32 s93, s79, 16
    s_lshr_b32 s94, s75, 1
    s_lshl_b32 s94, s94, 7
    s_add_u32 s93, s93, s94
    s_lshl_b32 s94, s79, 13
    s_add_u32 m0, s94, 0
    s_add_u32 s92, s93, 0
    buffer_load_dwordx4 v20, s[40:43], s92 offen lds
    s_add_u32 m0, s94, 1024
    s_add_u32 s92, s93, 8192
    buffer_load_dwordx4 v20, s[40:43], s92 offen lds
    s_add_u32 m0, s94, 2048
    s_add_u32 s92, s93, 16384
    buffer_load_dwordx4 v20, s[40:43], s92 offen lds
    s_add_u32 m0, s94, 3072
    s_add_u32 s92, s93, 24576
    buffer_load_dwordx4 v20, s[40:43], s92 offen lds
    v_mfma_f32_32x32x16_bf16 v[56:71], v[108:111], v[124:127], v[56:71]
    ds_read_b64_tr_b16 v[136:137], v12 offset:43008
    ds_read_b64_tr_b16 v[138:139], v12 offset:43520
    s_add_u32 m0, s94, 4096
    s_add_u32 s92, s93, 32768
    buffer_load_dwordx4 v20, s[40:43], s92 offen lds
    s_add_u32 m0, s94, 5120
    s_add_u32 s92, s93, 40960
    buffer_load_dwordx4 v20, s[40:43], s92 offen lds
    s_add_u32 m0, s94, 6144
    s_add_u32 s92, s93, 49152
    buffer_load_dwordx4 v20, s[40:43], s92 offen lds
    s_add_u32 m0, s94, 7168
    s_add_u32 s92, s93, 57344
    buffer_load_dwordx4 v20, s[40:43], s92 offen lds
    v_mfma_f32_16x16x32_bf16 v[76:79], v[112:115], v[128:131], v[76:79]
    ds_read_b64_tr_b16 v[140:141], v12 offset:51200
    ds_read_b64_tr_b16 v[142:143], v12 offset:51712
    ds_read_b128 v[112:115], v13 offset:34816
    ds_read_b64_tr_b16 v[144:145], v15 offset:43008
    ds_read_b64_tr_b16 v[146:147], v15 offset:43520
    s_waitcnt lgkmcnt(7)
    v_mfma_f32_32x32x16_bf16 v[24:39], v[132:135], v[104:107], v[24:39]
    ds_read_b128 v[108:111], v9 offset:34816
    ds_read_b64_tr_b16 v[148:149], v12 offset:36864
    ds_read_b64_tr_b16 v[150:151], v12 offset:37376
    s_waitcnt lgkmcnt(8)
    v_mfma_f32_32x32x16_bf16 v[40:55], v[136:139], v[104:107], v[40:55]
    ds_read_b64_tr_b16 v[152:153], v12 offset:45056
    ds_read_b64_tr_b16 v[154:155], v12 offset:45568
    s_waitcnt lgkmcnt(8)
    v_mfma_f32_32x32x16_bf16 v[56:71], v[104:107], v[140:143], v[56:71]
    ds_read_b64_tr_b16 v[156:157], v12 offset:53248
    ds_read_b64_tr_b16 v[158:159], v12 offset:53760
    s_waitcnt lgkmcnt(7)
    v_mfma_f32_16x16x32_bf16 v[72:75], v[144:147], v[112:115], v[72:75]
    ds_read_b64_tr_b16 v[160:161], v15 offset:51200
    ds_read_b64_tr_b16 v[162:163], v15 offset:51712
    s_waitcnt lgkmcnt(6)
    v_mfma_f32_32x32x16_bf16 v[24:39], v[148:151], v[108:111], v[24:39]
    ds_read_b128 v[104:107], v10 offset:34816
    ds_read_b64_tr_b16 v[116:117], v12 offset:38912
    ds_read_b64_tr_b16 v[118:119], v12 offset:39424
    s_waitcnt lgkmcnt(7)
    v_mfma_f32_32x32x16_bf16 v[40:55], v[152:155], v[108:111], v[40:55]
    ds_read_b64_tr_b16 v[120:121], v12 offset:47104
    ds_read_b64_tr_b16 v[122:123], v12 offset:47616
    s_waitcnt lgkmcnt(7)
    v_mfma_f32_32x32x16_bf16 v[56:71], v[108:111], v[156:159], v[56:71]
    ds_read_b64_tr_b16 v[124:125], v12 offset:55296
    ds_read_b64_tr_b16 v[126:127], v12 offset:55808
    s_waitcnt lgkmcnt(7)
    v_mfma_f32_16x16x32_bf16 v[76:79], v[112:115], v[160:163], v[76:79]
    ds_read_b128 v[112:115], v14 offset:34816
    ds_read_b64_tr_b16 v[128:129], v15 offset:47104
    ds_read_b64_tr_b16 v[130:131], v15 offset:47616
    s_waitcnt lgkmcnt(7)
    v_mfma_f32_32x32x16_bf16 v[24:39], v[116:119], v[104:107], v[24:39]
    ds_read_b128 v[108:111], v11 offset:34816
    ds_read_b64_tr_b16 v[132:133], v12 offset:40960
    ds_read_b64_tr_b16 v[134:135], v12 offset:41472
    s_waitcnt lgkmcnt(8)
    v_mfma_f32_32x32x16_bf16 v[40:55], v[120:123], v[104:107], v[40:55]
    ds_read_b64_tr_b16 v[136:137], v12 offset:49152
    ds_read_b64_tr_b16 v[138:139], v12 offset:49664
    s_waitcnt lgkmcnt(8)
    v_mfma_f32_32x32x16_bf16 v[56:71], v[104:107], v[124:127], v[56:71]
    ds_read_b64_tr_b16 v[140:141], v12 offset:57344
    ds_read_b64_tr_b16 v[142:143], v12 offset:57856
    s_waitcnt lgkmcnt(7)
    v_mfma_f32_16x16x32_bf16 v[72:75], v[128:131], v[112:115], v[72:75]
    ds_read_b64_tr_b16 v[144:145], v15 offset:55296
    ds_read_b64_tr_b16 v[146:147], v15 offset:55808
    s_waitcnt lgkmcnt(6)
    v_mfma_f32_32x32x16_bf16 v[24:39], v[132:135], v[108:111], v[24:39]
    s_waitcnt lgkmcnt(4)
    v_mfma_f32_32x32x16_bf16 v[40:55], v[136:139], v[108:111], v[40:55]
    s_waitcnt lgkmcnt(2)
    v_mfma_f32_32x32x16_bf16 v[56:71], v[108:111], v[140:143], v[56:71]
    s_waitcnt lgkmcnt(0)
    v_mfma_f32_16x16x32_bf16 v[76:79], v[112:115], v[144:147], v[76:79]
    s_setprio 3
    s_setprio 3
    v_bfe_u32 v9, v0, 3, 1
    v_lshlrev_b32 v10, 10, v9
    v_bfe_u32 v9, v0, 4, 1
    v_lshl_add_u32 v10, v9, 7, v10
    v_and_b32 v11, 7, v0
    v_lshl_add_u32 v10, v11, 4, v10
    v_lshrrev_b32 v12, 5, v0
    v_lshl_add_u32 v10, v12, 3, v10
    s_and_b32 s92, s79, 2
    s_lshl_b32 s92, s92, 10
    s_add_u32 s92, s92, 69632
    s_and_b32 s93, s79, 1
    s_lshl_b32 s94, s93, 8
    s_add_u32 s94, s94, s92
    v_add_u32 v10, s94, v10
    v_lshlrev_b32 v13, 10, v12
    v_lshl_add_u32 v13, v9, 8, v13
    v_and_b32 v14, 15, v0
    v_lshl_add_u32 v13, v14, 3, v13
    s_lshl_b32 s94, s93, 7
    s_add_u32 s94, s94, s92
    v_add_u32 v13, s94, v13
    v_cvt_pk_bf16_f32 v16, v72, v73
    v_cvt_pk_bf16_f32 v17, v74, v75
    v_cvt_pk_bf16_f32 v18, v76, v77
    v_cvt_pk_bf16_f32 v19, v78, v79
    ds_write_b64 v10, v[16:17]
    ds_write_b64 v13, v[18:19] offset:512
    s_mov_b64 exec, 1
    ds_add_u32 v5, v6 offset:0
    s_mov_b64 exec, -1
    s_lshl_b32 s92, s79, 10
    s_add_u32 s92, s92, 69632
    v_lshl_add_u32 v11, v12, 3, v11
    v_lshl_add_u32 v11, v11, 4, s92
    v_lshl_add_u32 v14, v0, 3, s92
    v_cvt_pk_bf16_f32 v112, v40, v41
    v_cvt_pk_bf16_f32 v113, v42, v43
    v_cvt_pk_bf16_f32 v114, v44, v45
    v_cvt_pk_bf16_f32 v115, v46, v47
    v_cvt_pk_bf16_f32 v116, v48, v49
    v_cvt_pk_bf16_f32 v117, v50, v51
    v_cvt_pk_bf16_f32 v118, v52, v53
    v_cvt_pk_bf16_f32 v119, v54, v55
    v_cvt_pk_bf16_f32 v104, v24, v25
    v_cvt_pk_bf16_f32 v105, v26, v27
    v_cvt_pk_bf16_f32 v106, v28, v29
    v_cvt_pk_bf16_f32 v107, v30, v31
    v_cvt_pk_bf16_f32 v108, v32, v33
    v_cvt_pk_bf16_f32 v109, v34, v35
    v_cvt_pk_bf16_f32 v110, v36, v37
    v_cvt_pk_bf16_f32 v111, v38, v39
L_poll_31:
    ds_read_b32 v7, v5 offset:0
    s_waitcnt lgkmcnt(0)
    v_readfirstlane_b32 s98, v7
    s_cmp_ge_u32 s98, 40
    s_cbranch_scc1 L_poll_31_d
    s_sleep 1
    s_add_u32 s100, s100, 1
    s_cmp_lt_u32 s100, 60000
    s_cbranch_scc1 L_poll_31
L_poll_31_d:
    ds_read_b128 v[128:131], v11
    ds_read_b128 v[132:135], v11 offset:256
    ds_read_b64 v[138:139], v14 offset:512
    s_setprio 1
    v_mfma_f32_32x32x16_bf16 v[24:39], v[112:115], v[104:107], v[80:95]
    v_mfma_f32_32x32x16_bf16 v[40:55], v[116:119], v[108:111], v[80:95]
    s_setprio 3
    s_lshl_b32 s93, s79, 16
    s_lshr_b32 s94, s75, 1
    s_lshl_b32 s94, s94, 7
    s_add_u32 s93, s93, s94
    s_lshl_b32 s94, s79, 13
    s_add_u32 m0, s94, 32768
    s_add_u32 s92, s93, 262144
    buffer_load_dwordx4 v20, s[40:43], s92 offen lds
    s_add_u32 m0, s94, 33792
    s_add_u32 s92, s93, 270336
    buffer_load_dwordx4 v20, s[40:43], s92 offen lds
    s_add_u32 m0, s94, 34816
    s_add_u32 s92, s93, 278528
    buffer_load_dwordx4 v20, s[40:43], s92 offen lds
    s_add_u32 m0, s94, 35840
    s_add_u32 s92, s93, 286720
    buffer_load_dwordx4 v20, s[40:43], s92 offen lds
    s_add_u32 m0, s94, 36864
    s_add_u32 s92, s93, 294912
    buffer_load_dwordx4 v20, s[40:43], s92 offen lds
    s_add_u32 m0, s94, 37888
    s_add_u32 s92, s93, 303104
    buffer_load_dwordx4 v20, s[40:43], s92 offen lds
    s_add_u32 m0, s94, 38912
    s_add_u32 s92, s93, 311296
    buffer_load_dwordx4 v20, s[40:43], s92 offen lds
    s_add_u32 m0, s94, 39936
    s_add_u32 s92, s93, 319488
    buffer_load_dwordx4 v20, s[40:43], s92 offen lds
    v_cvt_pk_bf16_f32 v120, v56, v57
    v_cvt_pk_bf16_f32 v121, v58, v59
    v_cvt_pk_bf16_f32 v122, v60, v61
    v_cvt_pk_bf16_f32 v123, v62, v63
    v_cvt_pk_bf16_f32 v124, v64, v65
    v_cvt_pk_bf16_f32 v125, v66, v67
    v_cvt_pk_bf16_f32 v126, v68, v69
    v_cvt_pk_bf16_f32 v127, v70, v71
    v_mov_b32 v136, 0
    v_mov_b32 v137, 0
    v_mov_b32 v140, 0
    v_mov_b32 v141, 0
    v_mov_b32 v142, 0
    v_mov_b32 v143, 0
    v_mov_b32 v144, 0
    v_mov_b32 v145, 0
    v_mov_b32 v146, 0
    v_mov_b32 v147, 0
    v_mov_b32 v148, 0
    v_mov_b32 v149, 0
    v_mov_b32 v150, 0
    v_mov_b32 v151, 0
    s_lshl_b32 s93, s72, 1
    s_and_b32 s94, s79, 1
    s_add_u32 s93, s93, s94
    s_lshl_b32 s93, s93, 15
    s_lshl_b32 s94, s73, 2
    s_and_b32 s95, s79, 2
    s_add_u32 s94, s94, s95
    s_lshl_b32 s94, s94, 10
    s_add_u32 s93, s93, s94
    s_add_u32 s93, s93, 0
    v_lshlrev_b32 v9, 4, v0
    v_mov_b32 v22, 0x3eb8aa3b
    s_waitcnt lgkmcnt(0)
    s_setprio 1
    v_mfma_f32_32x32x16_bf16 v[64:79], v[128:131], v[104:107], v[84:99]
    s_setprio 3
    v_max_f32 v152, v24, v32
    v_max_f32 v153, v25, v33
    v_max_f32 v154, v26, v34
    v_max_f32 v155, v27, v35
    v_max3_f32 v10, v152, v153, v154
    s_nop 0
    s_nop 0
    s_nop 0
    s_nop 0
    s_nop 0
    s_nop 0
    v_max3_f32 v156, v28, v36, v76
    v_max3_f32 v157, v29, v37, v77
    v_max3_f32 v158, v30, v38, v78
    v_max3_f32 v159, v31, v39, v79
    v_max3_f32 v10, v10, v155, v156
    v_max3_f32 v10, v10, v157, v158
    v_max_f32 v10, v10, v159
    v_mov_b32 v11, v10
    s_nop 0
    s_nop 0
    v_permlane32_swap_b32 v10, v11
    s_nop 0
    v_max_f32 v10, v10, v11
    v_mul_f32 v10, v22, v10
    v_pk_fma_f32 v[152:153], v[152:153], v[22:23], v[10:11] op_sel_hi:[1,0,0] neg_lo:[0,0,1] neg_hi:[0,0,1]
    v_pk_fma_f32 v[154:155], v[154:155], v[22:23], v[10:11] op_sel_hi:[1,0,0] neg_lo:[0,0,1] neg_hi:[0,0,1]
    v_pk_fma_f32 v[156:157], v[156:157], v[22:23], v[10:11] op_sel_hi:[1,0,0] neg_lo:[0,0,1] neg_hi:[0,0,1]
    v_pk_fma_f32 v[158:159], v[158:159], v[22:23], v[10:11] op_sel_hi:[1,0,0] neg_lo:[0,0,1] neg_hi:[0,0,1]
    v_exp_f32 v152, v152
    v_exp_f32 v153, v153
    v_exp_f32 v154, v154
    v_exp_f32 v155, v155
    v_exp_f32 v156, v156
    v_exp_f32 v157, v157
    v_exp_f32 v158, v158
    v_exp_f32 v159, v159
    s_mov_b32 exec_lo, 0xffff
    s_mov_b32 exec_hi, 0xffff
    v_cvt_pk_bf16_f32 v140, v152, v153
    v_cvt_pk_bf16_f32 v141, v154, v155
    s_mov_b32 exec_lo, 0xffff0000
    s_mov_b32 exec_hi, 0xffff0000
    v_cvt_pk_bf16_f32 v144, v152, v153
    v_cvt_pk_bf16_f32 v145, v154, v155
    s_mov_b32 exec_lo, 0xffff00
    s_mov_b32 exec_hi, 0xffff00
    v_cvt_pk_bf16_f32 v142, v156, v157
    v_cvt_pk_bf16_f32 v143, v158, v159
    s_mov_b32 exec_lo, 0xff000000
    s_mov_b32 exec_hi, 0xff000000
    v_cvt_pk_bf16_f32 v146, v156, v157
    v_cvt_pk_bf16_f32 v147, v158, v159
    s_mov_b32 exec_lo, 0xff
    s_mov_b32 exec_hi, 0xff
    v_cvt_pk_bf16_f32 v150, v156, v157
    v_cvt_pk_bf16_f32 v151, v158, v159
    s_mov_b64 exec, -1
    v_pk_add_f32 v[152:153], v[152:153], v[154:155]
    v_pk_add_f32 v[156:157], v[156:157], v[158:159]
    s_setprio 1
    v_mfma_f32_32x32x16_bf16 v[24:39], v[120:123], v[140:143], 0
    v_mfma_f32_32x32x16_bf16 v[24:39], v[124:127], v[144:147], v[24:39]
    v_mfma_f32_32x32x16_bf16 v[24:39], v[136:139], v[148:151], v[24:39]
    s_setprio 3
    v_pk_add_f32 v[152:153], v[152:153], v[156:157]
    v_add_f32 v10, v152, v153
    v_mov_b32 v11, v10
    s_nop 0
    s_nop 0
    v_permlane32_swap_b32 v10, v11
    s_nop 0
    v_add_f32 v10, v10, v11
    v_rcp_f32 v10, v10
    s_nop 0
    s_nop 0
    s_nop 0
    v_pk_mul_f32 v[24:25], v[24:25], v[10:11] op_sel_hi:[1,0]
    v_pk_mul_f32 v[26:27], v[26:27], v[10:11] op_sel_hi:[1,0]
    v_pk_mul_f32 v[28:29], v[28:29], v[10:11] op_sel_hi:[1,0]
    v_pk_mul_f32 v[30:31], v[30:31], v[10:11] op_sel_hi:[1,0]
    v_cvt_pk_bf16_f32 v12, v24, v25
    v_cvt_pk_bf16_f32 v13, v26, v27
    v_cvt_pk_bf16_f32 v14, v28, v29
    v_cvt_pk_bf16_f32 v15, v30, v31
    s_waitcnt vmcnt(0)
    s_mov_b64 exec, 1
    ds_add_u32 v5, v6 offset:24
    s_mov_b64 exec, -1
    buffer_store_dwordx4 v[12:15], v9, s[64:67], s93 offen offset:0 sc1
    s_setprio 1
    v_mfma_f32_32x32x16_bf16 v[64:79], v[132:135], v[108:111], v[84:99]
    s_setprio 3
    v_max_f32 v152, v40, v48
    v_max_f32 v153, v41, v49
    v_max_f32 v154, v42, v50
    v_max_f32 v155, v43, v51
    v_max3_f32 v10, v152, v153, v154
    s_nop 0
    s_nop 0
    s_nop 0
    s_nop 0
    s_nop 0
    s_nop 0
    v_max3_f32 v156, v44, v52, v76
    v_max3_f32 v157, v45, v53, v77
    v_max3_f32 v158, v46, v54, v78
    v_max3_f32 v159, v47, v55, v79
    v_max3_f32 v10, v10, v155, v156
    v_max3_f32 v10, v10, v157, v158
    v_max_f32 v10, v10, v159
    v_mov_b32 v11, v10
    s_nop 0
    s_nop 0
    v_permlane32_swap_b32 v10, v11
    s_nop 0
    v_max_f32 v10, v10, v11
    v_mul_f32 v10, v22, v10
    v_pk_fma_f32 v[152:153], v[152:153], v[22:23], v[10:11] op_sel_hi:[1,0,0] neg_lo:[0,0,1] neg_hi:[0,0,1]
    v_pk_fma_f32 v[154:155], v[154:155], v[22:23], v[10:11] op_sel_hi:[1,0,0] neg_lo:[0,0,1] neg_hi:[0,0,1]
    v_pk_fma_f32 v[156:157], v[156:157], v[22:23], v[10:11] op_sel_hi:[1,0,0] neg_lo:[0,0,1] neg_hi:[0,0,1]
    v_pk_fma_f32 v[158:159], v[158:159], v[22:23], v[10:11] op_sel_hi:[1,0,0] neg_lo:[0,0,1] neg_hi:[0,0,1]
    v_exp_f32 v152, v152
    v_exp_f32 v153, v153
    v_exp_f32 v154, v154
    v_exp_f32 v155, v155
    v_exp_f32 v156, v156
    v_exp_f32 v157, v157
    v_exp_f32 v158, v158
    v_exp_f32 v159, v159
    s_mov_b32 exec_lo, 0xffff
    s_mov_b32 exec_hi, 0xffff
    v_cvt_pk_bf16_f32 v140, v152, v153
    v_cvt_pk_bf16_f32 v141, v154, v155
    s_mov_b32 exec_lo, 0xffff0000
    s_mov_b32 exec_hi, 0xffff0000
    v_cvt_pk_bf16_f32 v144, v152, v153
    v_cvt_pk_bf16_f32 v145, v154, v155
    s_mov_b32 exec_lo, 0xffff00
    s_mov_b32 exec_hi, 0xffff00
    v_cvt_pk_bf16_f32 v142, v156, v157
    v_cvt_pk_bf16_f32 v143, v158, v159
    s_mov_b32 exec_lo, 0xff000000
    s_mov_b32 exec_hi, 0xff000000
    v_cvt_pk_bf16_f32 v146, v156, v157
    v_cvt_pk_bf16_f32 v147, v158, v159
    s_mov_b32 exec_lo, 0xff
    s_mov_b32 exec_hi, 0xff
    v_cvt_pk_bf16_f32 v150, v156, v157
    v_cvt_pk_bf16_f32 v151, v158, v159
    s_mov_b64 exec, -1
    v_pk_add_f32 v[152:153], v[152:153], v[154:155]
    v_pk_add_f32 v[156:157], v[156:157], v[158:159]
    s_setprio 1
    v_mfma_f32_32x32x16_bf16 v[40:55], v[120:123], v[140:143], 0
    v_mfma_f32_32x32x16_bf16 v[40:55], v[124:127], v[144:147], v[40:55]
    v_mfma_f32_32x32x16_bf16 v[40:55], v[136:139], v[148:151], v[40:55]
    s_setprio 3
    v_pk_add_f32 v[152:153], v[152:153], v[156:157]
    v_add_f32 v10, v152, v153
    v_mov_b32 v11, v10
    s_nop 0
    s_nop 0
    v_permlane32_swap_b32 v10, v11
    s_nop 0
    v_add_f32 v10, v10, v11
    v_rcp_f32 v10, v10
    s_nop 0
    s_nop 0
    s_nop 0
    v_pk_mul_f32 v[48:49], v[48:49], v[10:11] op_sel_hi:[1,0]
    v_pk_mul_f32 v[50:51], v[50:51], v[10:11] op_sel_hi:[1,0]
    v_pk_mul_f32 v[52:53], v[52:53], v[10:11] op_sel_hi:[1,0]
    v_pk_mul_f32 v[54:55], v[54:55], v[10:11] op_sel_hi:[1,0]
    v_cvt_pk_bf16_f32 v16, v48, v49
    v_cvt_pk_bf16_f32 v17, v50, v51
    v_cvt_pk_bf16_f32 v18, v52, v53
    v_cvt_pk_bf16_f32 v19, v54, v55
    buffer_store_dwordx4 v[16:19], v9, s[64:67], s93 offen offset:1024 sc1
    s_setprio 3
    s_lshl_b32 s97, s101, 2
    s_add_u32 s97, s97, s79
    s_lshl_b32 s97, s97, 7
    s_add_u32 s97, s97, 5570560
    s_mov_b32 s4, 0x1a2b0e37
    s_mov_b32 s5, 0xc9d1715
    s_mov_b32 s6, 0x1f6309c1
    s_mov_b32 s7, 0x5f71b8b
    v_lshlrev_b32 v1, 4, v0
    v_add_u32 v2, 162816, v1
    ds_read_b128 v[8:11], v2
    v_and_b32 v4, 3, v0
    v_lshlrev_b32 v4, 8, v4
    v_add_u32 v4, 161792, v4
    v_and_b32 v3, 31, v0
    v_lshlrev_b32 v3, 2, v3
    s_lshl_b32 s80, s74, 2
    s_add_u32 s80, s80, s79
    s_waitcnt vmcnt(0)
    v_mov_b32 v12, 0
    v_mov_b32 v13, s71
    s_mov_b64 exec, 1
    buffer_store_dword v13, v12, s[64:67], s97 offen sc1
    s_mov_b64 exec, -1
    s_cmp_eq_u32 s77, 0
    s_cbranch_scc1 L_latepub
    s_lshr_b32 s94, s80, 1
    s_lshl_b32 s81, s94, 17
    s_and_b32 s95, s79, 1
    s_lshl_b32 s92, s95, 11
    s_add_u32 s81, s81, s92
    s_lshl_b32 s92, s75, 6
    s_add_u32 s81, s81, s92
    s_add_u32 s81, s81, 960
    s_lshl_b32 s94, s94, 12
    s_lshl_b32 s95, s95, 7
    s_add_u32 s94, s94, s95
    s_add_u32 s94, s94, 5570560
    v_lshl_add_u32 v2, v0, 8, s94
    s_lshl_b32 s82, s80, 15
    s_add_u32 s82, s82, 0
    s_mov_b32 exec_lo, 0xffff
    s_mov_b32 exec_hi, 0x0
L_gp_32:
    buffer_load_dword v7, v2, s[64:67], 0 offen sc1
    s_waitcnt vmcnt(0)
    v_cmp_ne_u32 vcc, s71, v7
    s_and_b64 exec, exec, vcc
    s_cbranch_execz L_gp_32_d
    s_sleep 16
    s_add_u32 s100, s100, 1
    s_cmp_lt_u32 s100, 60000
    s_cbranch_scc1 L_gp_32
L_gp_32_d:
    s_mov_b64 exec, -1
    s_add_u32 s83, s82, 0
    buffer_load_dwordx4 v[48:51], v1, s[64:67], s83 offen offset:0 sc1
    s_add_u32 s83, s82, 0
    buffer_load_dwordx4 v[52:55], v1, s[64:67], s83 offen offset:1024 sc1
    s_add_u32 s83, s82, 0
    buffer_load_dwordx4 v[56:59], v1, s[64:67], s83 offen offset:2048 sc1
    s_add_u32 s83, s82, 0
    buffer_load_dwordx4 v[60:63], v1, s[64:67], s83 offen offset:3072 sc1
    s_add_u32 s83, s82, 4096
    buffer_load_dwordx4 v[64:67], v1, s[64:67], s83 offen offset:0 sc1
    s_waitcnt vmcnt(4)
    s_add_u32 s83, s82, 4096
    buffer_load_dwordx4 v[68:71], v1, s[64:67], s83 offen offset:1024 sc1
    s_waitcnt vmcnt(4)
    s_add_u32 s83, s82, 4096
    buffer_load_dwordx4 v[72:75], v1, s[64:67], s83 offen offset:2048 sc1
    s_waitcnt vmcnt(4)
    s_add_u32 s83, s82, 4096
    buffer_load_dwordx4 v[76:79], v1, s[64:67], s83 offen offset:3072 sc1
    s_waitcnt vmcnt(4)
    s_add_u32 s83, s82, 8192
    buffer_load_dwordx4 v[80:83], v1, s[64:67], s83 offen offset:0 sc1
    s_waitcnt vmcnt(4)
    s_add_u32 s83, s82, 8192
    buffer_load_dwordx4 v[84:87], v1, s[64:67], s83 offen offset:1024 sc1
    s_waitcnt vmcnt(4)
    s_add_u32 s83, s82, 8192
    buffer_load_dwordx4 v[88:91], v1, s[64:67], s83 offen offset:2048 sc1
    s_waitcnt vmcnt(4)
    s_add_u32 s83, s82, 8192
    buffer_load_dwordx4 v[92:95], v1, s[64:67], s83 offen offset:3072 sc1
    s_waitcnt vmcnt(4)
    s_add_u32 s83, s82, 12288
    buffer_load_dwordx4 v[96:99], v1, s[64:67], s83 offen offset:0 sc1
    s_waitcnt vmcnt(4)
    s_add_u32 s83, s82, 12288
    buffer_load_dwordx4 v[100:103], v1, s[64:67], s83 offen offset:1024 sc1
    s_waitcnt vmcnt(4)
    s_add_u32 s83, s82, 12288
    buffer_load_dwordx4 v[104:107], v1, s[64:67], s83 offen offset:2048 sc1
    s_waitcnt vmcnt(4)
    s_add_u32 s83, s82, 12288
    buffer_load_dwordx4 v[108:111], v1, s[64:67], s83 offen offset:3072 sc1
    s_waitcnt vmcnt(4)
    s_add_u32 s83, s82, 16384
    buffer_load_dwordx4 v[112:115], v1, s[64:67], s83 offen offset:0 sc1
    s_waitcnt vmcnt(4)
    s_add_u32 s83, s82, 16384
    buffer_load_dwordx4 v[116:119], v1, s[64:67], s83 offen offset:1024 sc1
    s_waitcnt vmcnt(4)
    s_add_u32 s83, s82, 16384
    buffer_load_dwordx4 v[120:123], v1, s[64:67], s83 offen offset:2048 sc1
    s_waitcnt vmcnt(4)
    s_add_u32 s83, s82, 16384
    buffer_load_dwordx4 v[124:127], v1, s[64:67], s83 offen offset:3072 sc1
    s_waitcnt vmcnt(4)
    s_add_u32 s83, s82, 20480
    buffer_load_dwordx4 v[128:131], v1, s[64:67], s83 offen offset:0 sc1
    s_waitcnt vmcnt(4)
L_poll_33:
    ds_read_b32 v7, v5 offset:24
    s_waitcnt lgkmcnt(0)
    v_readfirstlane_b32 s98, v7
    s_cmp_ge_u32 s98, 4
    s_cbranch_scc1 L_poll_33_d
    s_sleep 1
    s_add_u32 s100, s100, 1
    s_cmp_lt_u32 s100, 60000
    s_cbranch_scc1 L_poll_33
L_poll_33_d:
    v_lshl_add_u32 v11, v3, 9, v11
    v_xor_b32 v14, 64, v8
    s_setprio 2
    ds_read_b64_tr_b16 v[132:133], v8 offset:0
    ds_read_b64_tr_b16 v[134:135], v8 offset:1024
    ds_read_b64_tr_b16 v[136:137], v14 offset:0
    ds_read_b64_tr_b16 v[138:139], v14 offset:1024
    ds_read_b64_tr_b16 v[140:141], v8 offset:2048
    ds_read_b64_tr_b16 v[142:143], v8 offset:3072
    ds_read_b64_tr_b16 v[144:145], v14 offset:2048
    ds_read_b64_tr_b16 v[146:147], v14 offset:3072
    ds_read_b64_tr_b16 v[148:149], v8 offset:4096
    ds_read_b64_tr_b16 v[150:151], v8 offset:5120
    ds_read_b64_tr_b16 v[152:153], v14 offset:4096
    ds_read_b64_tr_b16 v[154:155], v14 offset:5120
    s_waitcnt vmcnt(4) lgkmcnt(8)
    v_mfma_f32_32x32x16_bf16 v[16:31], v[132:135], v[48:51], 0
    v_mfma_f32_32x32x16_bf16 v[32:47], v[136:139], v[48:51], 0
    s_add_u32 s83, s82, 20480
    buffer_load_dwordx4 v[48:51], v1, s[64:67], s83 offen offset:1024 sc1
    ds_read_b64_tr_b16 v[156:157], v8 offset:6144
    ds_read_b64_tr_b16 v[158:159], v8 offset:7168
    ds_read_b64_tr_b16 v[160:161], v14 offset:6144
    ds_read_b64_tr_b16 v[162:163], v14 offset:7168
    s_waitcnt vmcnt(4) lgkmcnt(8)
    v_mfma_f32_32x32x16_bf16 v[16:31], v[140:143], v[52:55], v[16:31]
    v_mfma_f32_32x32x16_bf16 v[32:47], v[144:147], v[52:55], v[32:47]
    s_add_u32 s83, s82, 20480
    buffer_load_dwordx4 v[52:55], v1, s[64:67], s83 offen offset:2048 sc1
    ds_read_b64_tr_b16 v[132:133], v8 offset:8192
    ds_read_b64_tr_b16 v[134:135], v8 offset:9216
    ds_read_b64_tr_b16 v[136:137], v14 offset:8192
    ds_read_b64_tr_b16 v[138:139], v14 offset:9216
    s_waitcnt vmcnt(4) lgkmcnt(8)
    v_mfma_f32_32x32x16_bf16 v[16:31], v[148:151], v[56:59], v[16:31]
    v_mfma_f32_32x32x16_bf16 v[32:47], v[152:155], v[56:59], v[32:47]
    s_add_u32 s83, s82, 20480
    buffer_load_dwordx4 v[56:59], v1, s[64:67], s83 offen offset:3072 sc1
    ds_read_b64_tr_b16 v[140:141], v8 offset:10240
    ds_read_b64_tr_b16 v[142:143], v8 offset:11264
    ds_read_b64_tr_b16 v[144:145], v14 offset:10240
    ds_read_b64_tr_b16 v[146:147], v14 offset:11264
    s_waitcnt vmcnt(4) lgkmcnt(8)
    v_mfma_f32_32x32x16_bf16 v[16:31], v[156:159], v[60:63], v[16:31]
    v_mfma_f32_32x32x16_bf16 v[32:47], v[160:163], v[60:63], v[32:47]
    s_add_u32 s83, s82, 24576
    buffer_load_dwordx4 v[60:63], v1, s[64:67], s83 offen offset:0 sc1
    ds_read_b64_tr_b16 v[148:149], v8 offset:12288
    ds_read_b64_tr_b16 v[150:151], v8 offset:13312
    ds_read_b64_tr_b16 v[152:153], v14 offset:12288
    ds_read_b64_tr_b16 v[154:155], v14 offset:13312
    s_waitcnt vmcnt(4) lgkmcnt(8)
    v_mfma_f32_32x32x16_bf16 v[16:31], v[132:135], v[64:67], v[16:31]
    v_mfma_f32_32x32x16_bf16 v[32:47], v[136:139], v[64:67], v[32:47]
    s_add_u32 s83, s82, 24576
    buffer_load_dwordx4 v[64:67], v1, s[64:67], s83 offen offset:1024 sc1
    ds_read_b64_tr_b16 v[156:157], v8 offset:14336
    ds_read_b64_tr_b16 v[158:159], v8 offset:15360
    ds_read_b64_tr_b16 v[160:161], v14 offset:14336
    ds_read_b64_tr_b16 v[162:163], v14 offset:15360
    s_waitcnt vmcnt(4) lgkmcnt(8)
    v_mfma_f32_32x32x16_bf16 v[16:31], v[140:143], v[68:71], v[16:31]
    v_mfma_f32_32x32x16_bf16 v[32:47], v[144:147], v[68:71], v[32:47]
    s_add_u32 s83, s82, 24576
    buffer_load_dwordx4 v[68:71], v1, s[64:67], s83 offen offset:2048 sc1
    ds_read_b64_tr_b16 v[132:133], v8 offset:16384
    ds_read_b64_tr_b16 v[134:135], v8 offset:17408
    ds_read_b64_tr_b16 v[136:137], v14 offset:16384
    ds_read_b64_tr_b16 v[138:139], v14 offset:17408
    s_waitcnt vmcnt(4) lgkmcnt(8)
    v_mfma_f32_32x32x16_bf16 v[16:31], v[148:151], v[72:75], v[16:31]
    v_mfma_f32_32x32x16_bf16 v[32:47], v[152:155], v[72:75], v[32:47]
    s_add_u32 s83, s82, 24576
    buffer_load_dwordx4 v[72:75], v1, s[64:67], s83 offen offset:3072 sc1
    ds_read_b64_tr_b16 v[140:141], v8 offset:18432
    ds_read_b64_tr_b16 v[142:143], v8 offset:19456
    ds_read_b64_tr_b16 v[144:145], v14 offset:18432
    ds_read_b64_tr_b16 v[146:147], v14 offset:19456
    s_waitcnt vmcnt(4) lgkmcnt(8)
    v_mfma_f32_32x32x16_bf16 v[16:31], v[156:159], v[76:79], v[16:31]
    v_mfma_f32_32x32x16_bf16 v[32:47], v[160:163], v[76:79], v[32:47]
    s_add_u32 s83, s82, 28672
    buffer_load_dwordx4 v[76:79], v1, s[64:67], s83 offen offset:0 sc1
    ds_read_b64_tr_b16 v[148:149], v8 offset:20480
    ds_read_b64_tr_b16 v[150:151], v8 offset:21504
    ds_read_b64_tr_b16 v[152:153], v14 offset:20480
    ds_read_b64_tr_b16 v[154:155], v14 offset:21504
    s_waitcnt vmcnt(4) lgkmcnt(8)
    v_mfma_f32_32x32x16_bf16 v[16:31], v[132:135], v[80:83], v[16:31]
    v_mfma_f32_32x32x16_bf16 v[32:47], v[136:139], v[80:83], v[32:47]
    s_add_u32 s83, s82, 28672
    buffer_load_dwordx4 v[80:83], v1, s[64:67], s83 offen offset:1024 sc1
    s_waitcnt vmcnt(4) lgkmcnt(4)
    v_mfma_f32_32x32x16_bf16 v[16:31], v[140:143], v[84:87], v[16:31]
    v_mfma_f32_32x32x16_bf16 v[32:47], v[144:147], v[84:87], v[32:47]
    s_add_u32 s83, s82, 28672
    buffer_load_dwordx4 v[84:87], v1, s[64:67], s83 offen offset:2048 sc1
    s_waitcnt vmcnt(4) lgkmcnt(0)
    v_mfma_f32_32x32x16_bf16 v[16:31], v[148:151], v[88:91], v[16:31]
    v_mfma_f32_32x32x16_bf16 v[32:47], v[152:155], v[88:91], v[32:47]
    s_add_u32 s83, s82, 28672
    buffer_load_dwordx4 v[88:91], v1, s[64:67], s83 offen offset:3072 sc1
    ds_read_b64_tr_b16 v[132:133], v8 offset:22528
    ds_read_b64_tr_b16 v[134:135], v8 offset:23552
    ds_read_b64_tr_b16 v[136:137], v14 offset:22528
    ds_read_b64_tr_b16 v[138:139], v14 offset:23552
    ds_read_b64_tr_b16 v[140:141], v8 offset:24576
    ds_read_b64_tr_b16 v[142:143], v8 offset:25600
    ds_read_b64_tr_b16 v[144:145], v14 offset:24576
    ds_read_b64_tr_b16 v[146:147], v14 offset:25600
L_poll_34:
    ds_read_b32 v7, v5 offset:20
    s_waitcnt lgkmcnt(0)
    v_readfirstlane_b32 s98, v7
    s_cmp_ge_u32 s98, 1
    s_cbranch_scc1 L_poll_34_d
    s_sleep 20
    s_add_u32 s100, s100, 1
    s_cmp_lt_u32 s100, 60000
    s_cbranch_scc1 L_poll_34
L_poll_34_d:
    s_setprio 1
    ds_read_b64_tr_b16 v[148:149], v8 offset:26624
    ds_read_b64_tr_b16 v[150:151], v8 offset:27648
    ds_read_b64_tr_b16 v[152:153], v14 offset:26624
    ds_read_b64_tr_b16 v[154:155], v14 offset:27648
    s_waitcnt vmcnt(20) lgkmcnt(8)
    v_mfma_f32_32x32x16_bf16 v[16:31], v[132:135], v[92:95], v[16:31]
    v_mfma_f32_32x32x16_bf16 v[32:47], v[136:139], v[92:95], v[32:47]
    ds_read_b64_tr_b16 v[156:157], v8 offset:28672
    ds_read_b64_tr_b16 v[158:159], v8 offset:29696
    ds_read_b64_tr_b16 v[160:161], v14 offset:28672
    ds_read_b64_tr_b16 v[162:163], v14 offset:29696
    s_waitcnt vmcnt(19) lgkmcnt(8)
    v_mfma_f32_32x32x16_bf16 v[16:31], v[140:143], v[96:99], v[16:31]
    v_mfma_f32_32x32x16_bf16 v[32:47], v[144:147], v[96:99], v[32:47]
    ds_read_b64_tr_b16 v[132:133], v8 offset:30720
    ds_read_b64_tr_b16 v[134:135], v8 offset:31744
    ds_read_b64_tr_b16 v[136:137], v14 offset:30720
    ds_read_b64_tr_b16 v[138:139], v14 offset:31744
    s_waitcnt vmcnt(18) lgkmcnt(8)
    v_mfma_f32_32x32x16_bf16 v[16:31], v[148:151], v[100:103], v[16:31]
    v_mfma_f32_32x32x16_bf16 v[32:47], v[152:155], v[100:103], v[32:47]
    ds_read_b64_tr_b16 v[140:141], v8 offset:32768
    ds_read_b64_tr_b16 v[142:143], v8 offset:33792
    ds_read_b64_tr_b16 v[144:145], v14 offset:32768
    ds_read_b64_tr_b16 v[146:147], v14 offset:33792
    s_waitcnt vmcnt(17) lgkmcnt(8)
    v_mfma_f32_32x32x16_bf16 v[16:31], v[156:159], v[104:107], v[16:31]
    v_mfma_f32_32x32x16_bf16 v[32:47], v[160:163], v[104:107], v[32:47]
    ds_read_b64_tr_b16 v[148:149], v8 offset:34816
    ds_read_b64_tr_b16 v[150:151], v8 offset:35840
    ds_read_b64_tr_b16 v[152:153], v14 offset:34816
    ds_read_b64_tr_b16 v[154:155], v14 offset:35840
    s_waitcnt vmcnt(16) lgkmcnt(8)
    v_mfma_f32_32x32x16_bf16 v[16:31], v[132:135], v[108:111], v[16:31]
    v_mfma_f32_32x32x16_bf16 v[32:47], v[136:139], v[108:111], v[32:47]
    ds_read_b64_tr_b16 v[156:157], v8 offset:36864
    ds_read_b64_tr_b16 v[158:159], v8 offset:37888
    ds_read_b64_tr_b16 v[160:161], v14 offset:36864
    ds_read_b64_tr_b16 v[162:163], v14 offset:37888
    s_waitcnt vmcnt(15) lgkmcnt(8)
    v_mfma_f32_32x32x16_bf16 v[16:31], v[140:143], v[112:115], v[16:31]
    v_mfma_f32_32x32x16_bf16 v[32:47], v[144:147], v[112:115], v[32:47]
    ds_read_b64_tr_b16 v[132:133], v8 offset:38912
    ds_read_b64_tr_b16 v[134:135], v8 offset:39936
    ds_read_b64_tr_b16 v[136:137], v14 offset:38912
    ds_read_b64_tr_b16 v[138:139], v14 offset:39936
    s_waitcnt vmcnt(14) lgkmcnt(8)
    v_mfma_f32_32x32x16_bf16 v[16:31], v[148:151], v[116:119], v[16:31]
    v_mfma_f32_32x32x16_bf16 v[32:47], v[152:155], v[116:119], v[32:47]
    ds_read_b64_tr_b16 v[140:141], v8 offset:40960
    ds_read_b64_tr_b16 v[142:143], v8 offset:41984
    ds_read_b64_tr_b16 v[144:145], v14 offset:40960
    ds_read_b64_tr_b16 v[146:147], v14 offset:41984
    s_waitcnt vmcnt(13) lgkmcnt(8)
    v_mfma_f32_32x32x16_bf16 v[16:31], v[156:159], v[120:123], v[16:31]
    v_mfma_f32_32x32x16_bf16 v[32:47], v[160:163], v[120:123], v[32:47]
    ds_read_b64_tr_b16 v[148:149], v8 offset:43008
    ds_read_b64_tr_b16 v[150:151], v8 offset:44032
    ds_read_b64_tr_b16 v[152:153], v14 offset:43008
    ds_read_b64_tr_b16 v[154:155], v14 offset:44032
    s_waitcnt vmcnt(12) lgkmcnt(8)
    v_mfma_f32_32x32x16_bf16 v[16:31], v[132:135], v[124:127], v[16:31]
    v_mfma_f32_32x32x16_bf16 v[32:47], v[136:139], v[124:127], v[32:47]
    ds_read_b64_tr_b16 v[156:157], v8 offset:45056
    ds_read_b64_tr_b16 v[158:159], v8 offset:46080
    ds_read_b64_tr_b16 v[160:161], v14 offset:45056
    ds_read_b64_tr_b16 v[162:163], v14 offset:46080
    s_waitcnt vmcnt(11) lgkmcnt(8)
    v_mfma_f32_32x32x16_bf16 v[16:31], v[140:143], v[128:131], v[16:31]
    v_mfma_f32_32x32x16_bf16 v[32:47], v[144:147], v[128:131], v[32:47]
    ds_read_b64_tr_b16 v[132:133], v8 offset:47104
    ds_read_b64_tr_b16 v[134:135], v8 offset:48128
    ds_read_b64_tr_b16 v[136:137], v14 offset:47104
    ds_read_b64_tr_b16 v[138:139], v14 offset:48128
    s_waitcnt vmcnt(10) lgkmcnt(8)
    v_mfma_f32_32x32x16_bf16 v[16:31], v[148:151], v[48:51], v[16:31]
    v_mfma_f32_32x32x16_bf16 v[32:47], v[152:155], v[48:51], v[32:47]
    ds_read_b64_tr_b16 v[140:141], v8 offset:49152
    ds_read_b64_tr_b16 v[142:143], v8 offset:50176
    ds_read_b64_tr_b16 v[144:145], v14 offset:49152
    ds_read_b64_tr_b16 v[146:147], v14 offset:50176
    s_waitcnt vmcnt(9) lgkmcnt(8)
    v_mfma_f32_32x32x16_bf16 v[16:31], v[156:159], v[52:55], v[16:31]
    v_mfma_f32_32x32x16_bf16 v[32:47], v[160:163], v[52:55], v[32:47]
    ds_read_b64_tr_b16 v[148:149], v8 offset:51200
    ds_read_b64_tr_b16 v[150:151], v8 offset:52224
    ds_read_b64_tr_b16 v[152:153], v14 offset:51200
    ds_read_b64_tr_b16 v[154:155], v14 offset:52224
    s_waitcnt vmcnt(8) lgkmcnt(8)
    v_mfma_f32_32x32x16_bf16 v[16:31], v[132:135], v[56:59], v[16:31]
    v_mfma_f32_32x32x16_bf16 v[32:47], v[136:139], v[56:59], v[32:47]
    ds_read_b64_tr_b16 v[156:157], v8 offset:53248
    ds_read_b64_tr_b16 v[158:159], v8 offset:54272
    ds_read_b64_tr_b16 v[160:161], v14 offset:53248
    ds_read_b64_tr_b16 v[162:163], v14 offset:54272
    s_waitcnt vmcnt(7) lgkmcnt(8)
    v_mfma_f32_32x32x16_bf16 v[16:31], v[140:143], v[60:63], v[16:31]
    v_mfma_f32_32x32x16_bf16 v[32:47], v[144:147], v[60:63], v[32:47]
    ds_read_b64_tr_b16 v[132:133], v8 offset:55296
    ds_read_b64_tr_b16 v[134:135], v8 offset:56320
    ds_read_b64_tr_b16 v[136:137], v14 offset:55296
    ds_read_b64_tr_b16 v[138:139], v14 offset:56320
    s_waitcnt vmcnt(6) lgkmcnt(8)
    v_mfma_f32_32x32x16_bf16 v[16:31], v[148:151], v[64:67], v[16:31]
    v_mfma_f32_32x32x16_bf16 v[32:47], v[152:155], v[64:67], v[32:47]
    ds_read_b64_tr_b16 v[140:141], v8 offset:57344
    ds_read_b64_tr_b16 v[142:143], v8 offset:58368
    ds_read_b64_tr_b16 v[144:145], v14 offset:57344
    ds_read_b64_tr_b16 v[146:147], v14 offset:58368
    s_waitcnt vmcnt(5) lgkmcnt(8)
    v_mfma_f32_32x32x16_bf16 v[16:31], v[156:159], v[68:71], v[16:31]
    v_mfma_f32_32x32x16_bf16 v[32:47], v[160:163], v[68:71], v[32:47]
    ds_read_b64_tr_b16 v[148:149], v8 offset:59392
    ds_read_b64_tr_b16 v[150:151], v8 offset:60416
    ds_read_b64_tr_b16 v[152:153], v14 offset:59392
    ds_read_b64_tr_b16 v[154:155], v14 offset:60416
    s_waitcnt vmcnt(4) lgkmcnt(8)
    v_mfma_f32_32x32x16_bf16 v[16:31], v[132:135], v[72:75], v[16:31]
    v_mfma_f32_32x32x16_bf16 v[32:47], v[136:139], v[72:75], v[32:47]
    ds_read_b64_tr_b16 v[156:157], v8 offset:61440
    ds_read_b64_tr_b16 v[158:159], v8 offset:62464
    ds_read_b64_tr_b16 v[160:161], v14 offset:61440
    ds_read_b64_tr_b16 v[162:163], v14 offset:62464
    s_waitcnt vmcnt(3) lgkmcnt(8)
    v_mfma_f32_32x32x16_bf16 v[16:31], v[140:143], v[76:79], v[16:31]
    v_mfma_f32_32x32x16_bf16 v[32:47], v[144:147], v[76:79], v[32:47]
    ds_read_b64_tr_b16 v[132:133], v8 offset:63488
    ds_read_b64_tr_b16 v[134:135], v8 offset:64512
    ds_read_b64_tr_b16 v[136:137], v14 offset:63488
    ds_read_b64_tr_b16 v[138:139], v14 offset:64512
    s_waitcnt vmcnt(2) lgkmcnt(8)
    v_mfma_f32_32x32x16_bf16 v[16:31], v[148:151], v[80:83], v[16:31]
    v_mfma_f32_32x32x16_bf16 v[32:47], v[152:155], v[80:83], v[32:47]
    s_waitcnt vmcnt(1) lgkmcnt(4)
    v_mfma_f32_32x32x16_bf16 v[16:31], v[156:159], v[84:87], v[16:31]
    v_mfma_f32_32x32x16_bf16 v[32:47], v[160:163], v[84:87], v[32:47]
    s_waitcnt vmcnt(0) lgkmcnt(0)
    v_mfma_f32_32x32x16_bf16 v[16:31], v[132:135], v[88:91], v[16:31]
    v_mfma_f32_32x32x16_bf16 v[32:47], v[136:139], v[88:91], v[32:47]
    s_nop 0
    s_nop 0
    s_nop 0
    s_nop 0
    s_nop 0
    s_nop 0
    s_nop 0
    s_nop 0
    s_nop 0
    s_nop 0
    s_nop 0
    v_cvt_pk_bf16_f32 v132, v16, v17
    v_cvt_pk_bf16_f32 v133, v18, v19
    v_cvt_pk_bf16_f32 v134, v20, v21
    v_cvt_pk_bf16_f32 v135, v22, v23
    v_cvt_pk_bf16_f32 v136, v24, v25
    v_cvt_pk_bf16_f32 v137, v26, v27
    v_cvt_pk_bf16_f32 v138, v28, v29
    v_cvt_pk_bf16_f32 v139, v30, v31
    buffer_store_dwordx4 v[132:135], v11, s[60:63], s81 offen offset:0
    buffer_store_dwordx4 v[136:139], v11, s[60:63], s81 offen offset:16
    v_cvt_pk_bf16_f32 v140, v32, v33
    v_cvt_pk_bf16_f32 v141, v34, v35
    v_cvt_pk_bf16_f32 v142, v36, v37
    v_cvt_pk_bf16_f32 v143, v38, v39
    v_cvt_pk_bf16_f32 v144, v40, v41
    v_cvt_pk_bf16_f32 v145, v42, v43
    v_cvt_pk_bf16_f32 v146, v44, v45
    v_cvt_pk_bf16_f32 v147, v46, v47
    buffer_store_dwordx4 v[140:143], v11, s[60:63], s81 offen offset:64
    buffer_store_dwordx4 v[144:147], v11, s[60:63], s81 offen offset:80
    s_endpgm
L_f3:
    s_load_dwordx2 s[60:61], s[0:1], 64
    s_mov_b32 s62, 0x400000
    s_mov_b32 s63, 0x20000
    v_mbcnt_lo_u32_b32 v0, -1, 0
    v_mbcnt_hi_u32_b32 v0, -1, v0
    s_mov_b32 s4, 0x1a2b0e37
    s_mov_b32 s5, 0xc9d1715
    s_mov_b32 s6, 0x1f6309c1
    s_mov_b32 s7, 0x5f71b8b
    v_lshlrev_b32 v1, 4, v0
    v_add_u32 v2, 162816, v1
    ds_read_b128 v[8:11], v2
    v_and_b32 v4, 3, v0
    v_lshlrev_b32 v4, 8, v4
    v_add_u32 v4, 161792, v4
    v_and_b32 v3, 31, v0
    v_lshlrev_b32 v3, 2, v3
    s_lshl_b32 s80, s74, 2
    s_add_u32 s80, s80, s79
    v_mov_b32 v5, 160256
    s_add_u32 s96, s79, 0
    s_mov_b32 s78, 0
    s_mul_i32 s92, s96, 9216
    s_add_u32 s92, s92, 64512
L_hp_35:
    ds_read_b32 v7, v4
    s_waitcnt lgkmcnt(0)
    v_cmp_gt_u32 vcc, s92, v7
    s_cbranch_vccz L_hp_35_d
    s_sleep 20
    s_add_u32 s100, s100, 1
    s_cmp_lt_u32 s100, 60000
    s_cbranch_scc1 L_hp_35
L_hp_35_d:
    s_branch L_pub
L_pub_ret0:
    s_cmp_lg_u32 s77, 0
    s_cbranch_scc1 L_latepub
    s_lshl_b32 s81, s80, 16
    s_lshl_b32 s92, s75, 6
    s_add_u32 s81, s81, s92
    v_xor_b32 v14, 64, v8
    s_mul_i32 s83, s80, 40960
    s_add_u32 s83, s83, 2097152
    s_mov_b32 s82, s83
    s_mov_b32 s86, 0
    s_and_b32 s87, s79, 1
    s_lshr_b32 s88, s80, 1
    s_lshl_b32 s88, s88, 13
    s_add_u32 s88, s88, 5767168
    s_mul_i32 s89, s87, 9216
    s_add_u32 s92, s83, 8419328
    buffer_load_dword v6, v9, s[64:67], s92 offen sc1
    s_add_u32 s92, s92, 8192
    s_mov_b64 exec, 0xffff
    buffer_load_dword v6, v9, s[64:67], s92 offen sc1
    s_mov_b64 exec, -1
    s_add_u32 s93, s89, 101376
L_hp_36:
    ds_read_b32 v7, v4
    s_waitcnt lgkmcnt(0)
    v_cmp_gt_u32 vcc, s93, v7
    s_cbranch_vccz L_hp_36_d
    s_sleep 20
    s_add_u32 s100, s100, 1
    s_cmp_lt_u32 s100, 60000
    s_cbranch_scc1 L_hp_36
L_hp_36_d:
    s_lshl_b32 exec_lo, 0x5050505, s87
    s_mov_b32 exec_hi, exec_lo
L_gp_37:
    buffer_load_dword v7, v9, s[64:67], s88 offen sc1
    s_waitcnt vmcnt(0)
    v_cmp_ne_u32 vcc, s71, v7
    s_and_b64 exec, exec, vcc
    s_cbranch_execz L_gp_37_d
    s_sleep 6
    s_add_u32 s100, s100, 1
    s_cmp_lt_u32 s100, 60000
    s_cbranch_scc1 L_gp_37
L_gp_37_d:
    s_mov_b64 exec, -1
    s_add_u32 s92, s82, 0
    buffer_load_dwordx4 v[48:51], v1, s[64:67], s92 offen sc1
    s_add_u32 s92, s82, 1280
    buffer_load_dwordx4 v[52:55], v1, s[64:67], s92 offen sc1
    s_add_u32 s92, s82, 2560
    buffer_load_dwordx4 v[56:59], v1, s[64:67], s92 offen sc1
    s_add_u32 s92, s82, 3840
    buffer_load_dwordx4 v[60:63], v1, s[64:67], s92 offen sc1
    s_add_u32 s92, s82, 5120
    buffer_load_dwordx4 v[64:67], v1, s[64:67], s92 offen sc1
    s_add_u32 s92, s82, 6400
    buffer_load_dwordx4 v[68:71], v1, s[64:67], s92 offen sc1
    s_add_u32 s92, s82, 7680
    buffer_load_dwordx4 v[72:75], v1, s[64:67], s92 offen sc1
    s_add_u32 s92, s82, 8960
    buffer_load_dwordx4 v[76:79], v1, s[64:67], s92 offen sc1
    s_add_u32 s92, s82, 10240
    buffer_load_dwordx4 v[80:83], v1, s[64:67], s92 offen sc1
    buffer_load_dword v112, v10, s[64:67], s92 offen offset:1024 sc1
    s_add_u32 s92, s82, 11520
    buffer_load_dwordx4 v[84:87], v1, s[64:67], s92 offen sc1
    buffer_load_dword v113, v10, s[64:67], s92 offen offset:1024 sc1
    s_add_u32 s92, s82, 12800
    buffer_load_dwordx4 v[88:91], v1, s[64:67], s92 offen sc1
    buffer_load_dword v114, v10, s[64:67], s92 offen offset:1024 sc1
    s_add_u32 s92, s82, 14080
    buffer_load_dwordx4 v[92:95], v1, s[64:67], s92 offen sc1
    buffer_load_dword v115, v10, s[64:67], s92 offen offset:1024 sc1
    s_add_u32 s92, s82, 15360
    buffer_load_dwordx4 v[96:99], v1, s[64:67], s92 offen sc1
    buffer_load_dword v116, v10, s[64:67], s92 offen offset:1024 sc1
    s_add_u32 s92, s82, 16640
    buffer_load_dwordx4 v[100:103], v1, s[64:67], s92 offen sc1
    buffer_load_dword v117, v10, s[64:67], s92 offen offset:1024 sc1
    s_add_u32 s92, s82, 17920
    buffer_load_dwordx4 v[104:107], v1, s[64:67], s92 offen sc1
    buffer_load_dword v118, v10, s[64:67], s92 offen offset:1024 sc1
    s_add_u32 s92, s82, 19200
    buffer_load_dwordx4 v[108:111], v1, s[64:67], s92 offen sc1
    buffer_load_dword v119, v10, s[64:67], s92 offen offset:1024 sc1
L_poll_38:
    ds_read_b32 v7, v5 offset:24
    s_waitcnt lgkmcnt(0)
    v_readfirstlane_b32 s98, v7
    s_cmp_ge_u32 s98, 4
    s_cbranch_scc1 L_poll_38_d
    s_sleep 8
    s_add_u32 s100, s100, 1
    s_cmp_lt_u32 s100, 60000
    s_cbranch_scc1 L_poll_38
L_poll_38_d:
    s_setprio 2
    ds_read_b64_tr_b16 v[132:133], v8 offset:0
    ds_read_b64_tr_b16 v[134:135], v8 offset:1024
    ds_read_b64_tr_b16 v[136:137], v14 offset:0
    ds_read_b64_tr_b16 v[138:139], v14 offset:1024
    ds_read_b64_tr_b16 v[140:141], v8 offset:8192
    ds_read_b64_tr_b16 v[142:143], v8 offset:9216
    ds_read_b64_tr_b16 v[144:145], v14 offset:8192
    ds_read_b64_tr_b16 v[146:147], v14 offset:9216
    ds_read_b64_tr_b16 v[148:149], v8 offset:16384
    ds_read_b64_tr_b16 v[150:151], v8 offset:17408
    ds_read_b64_tr_b16 v[152:153], v14 offset:16384
    ds_read_b64_tr_b16 v[154:155], v14 offset:17408
    s_waitcnt vmcnt(23) lgkmcnt(8)
    v_mfma_f32_32x32x16_bf16 v[16:31], v[132:135], v[48:51], 0
    v_mfma_f32_32x32x16_bf16 v[32:47], v[136:139], v[48:51], 0
    ds_read_b64_tr_b16 v[156:157], v8 offset:24576
    ds_read_b64_tr_b16 v[158:159], v8 offset:25600
    ds_read_b64_tr_b16 v[160:161], v14 offset:24576
    ds_read_b64_tr_b16 v[162:163], v14 offset:25600
    s_waitcnt vmcnt(22) lgkmcnt(8)
    v_mfma_f32_32x32x16_bf16 v[16:31], v[140:143], v[52:55], v[16:31]
    v_mfma_f32_32x32x16_bf16 v[32:47], v[144:147], v[52:55], v[32:47]
    ds_read_b64_tr_b16 v[132:133], v8 offset:32768
    ds_read_b64_tr_b16 v[134:135], v8 offset:33792
    ds_read_b64_tr_b16 v[136:137], v14 offset:32768
    ds_read_b64_tr_b16 v[138:139], v14 offset:33792
    s_waitcnt vmcnt(21) lgkmcnt(8)
    v_mfma_f32_32x32x16_bf16 v[16:31], v[148:151], v[56:59], v[16:31]
    v_mfma_f32_32x32x16_bf16 v[32:47], v[152:155], v[56:59], v[32:47]
    ds_read_b64_tr_b16 v[140:141], v8 offset:40960
    ds_read_b64_tr_b16 v[142:143], v8 offset:41984
    ds_read_b64_tr_b16 v[144:145], v14 offset:40960
    ds_read_b64_tr_b16 v[146:147], v14 offset:41984
    s_waitcnt vmcnt(20) lgkmcnt(8)
    v_mfma_f32_32x32x16_bf16 v[16:31], v[156:159], v[60:63], v[16:31]
    v_mfma_f32_32x32x16_bf16 v[32:47], v[160:163], v[60:63], v[32:47]
    ds_read_b64_tr_b16 v[148:149], v8 offset:49152
    ds_read_b64_tr_b16 v[150:151], v8 offset:50176
    ds_read_b64_tr_b16 v[152:153], v14 offset:49152
    ds_read_b64_tr_b16 v[154:155], v14 offset:50176
    s_waitcnt vmcnt(19) lgkmcnt(8)
    v_mfma_f32_32x32x16_bf16 v[16:31], v[132:135], v[64:67], v[16:31]
    v_mfma_f32_32x32x16_bf16 v[32:47], v[136:139], v[64:67], v[32:47]
    ds_read_b64_tr_b16 v[156:157], v8 offset:57344
    ds_read_b64_tr_b16 v[158:159], v8 offset:58368
    ds_read_b64_tr_b16 v[160:161], v14 offset:57344
    ds_read_b64_tr_b16 v[162:163], v14 offset:58368
    s_waitcnt vmcnt(18) lgkmcnt(8)
    v_mfma_f32_32x32x16_bf16 v[16:31], v[140:143], v[68:71], v[16:31]
    v_mfma_f32_32x32x16_bf16 v[32:47], v[144:147], v[68:71], v[32:47]
    s_waitcnt vmcnt(17) lgkmcnt(4)
    v_mfma_f32_32x32x16_bf16 v[16:31], v[148:151], v[72:75], v[16:31]
    v_mfma_f32_32x32x16_bf16 v[32:47], v[152:155], v[72:75], v[32:47]
    s_waitcnt vmcnt(16) lgkmcnt(0)
    v_mfma_f32_32x32x16_bf16 v[16:31], v[156:159], v[76:79], v[16:31]
    v_mfma_f32_32x32x16_bf16 v[32:47], v[160:163], v[76:79], v[32:47]
    ds_read_b64_tr_b16 v[132:133], v8 offset:2048
    ds_read_b64_tr_b16 v[134:135], v8 offset:3072
    ds_read_b64_tr_b16 v[136:137], v14 offset:2048
    ds_read_b64_tr_b16 v[138:139], v14 offset:3072
    ds_read_b64_tr_b16 v[140:141], v8 offset:10240
    ds_read_b64_tr_b16 v[142:143], v8 offset:11264
    ds_read_b64_tr_b16 v[144:145], v14 offset:10240
    ds_read_b64_tr_b16 v[146:147], v14 offset:11264
    s_waitcnt vmcnt(0)
    s_branch L_vf_39_v
L_vf_39:
    s_add_u32 s92, s82, 10240
    buffer_load_dwordx4 v[80:83], v1, s[64:67], s92 offen sc1
    buffer_load_dword v112, v10, s[64:67], s92 offen offset:1024 sc1
    s_add_u32 s92, s82, 11520
    buffer_load_dwordx4 v[84:87], v1, s[64:67], s92 offen sc1
    buffer_load_dword v113, v10, s[64:67], s92 offen offset:1024 sc1
    s_add_u32 s92, s82, 12800
    buffer_load_dwordx4 v[88:91], v1, s[64:67], s92 offen sc1
    buffer_load_dword v114, v10, s[64:67], s92 offen offset:1024 sc1
    s_add_u32 s92, s82, 14080
    buffer_load_dwordx4 v[92:95], v1, s[64:67], s92 offen sc1
    buffer_load_dword v115, v10, s[64:67], s92 offen offset:1024 sc1
    s_add_u32 s92, s82, 15360
    buffer_load_dwordx4 v[96:99], v1, s[64:67], s92 offen sc1
    buffer_load_dword v116, v10, s[64:67], s92 offen offset:1024 sc1
    s_add_u32 s92, s82, 16640
    buffer_load_dwordx4 v[100:103], v1, s[64:67], s92 offen sc1
    buffer_load_dword v117, v10, s[64:67], s92 offen offset:1024 sc1
    s_add_u32 s92, s82, 17920
    buffer_load_dwordx4 v[104:107], v1, s[64:67], s92 offen sc1
    buffer_load_dword v118, v10, s[64:67], s92 offen offset:1024 sc1
    s_add_u32 s92, s82, 19200
    buffer_load_dwordx4 v[108:111], v1, s[64:67], s92 offen sc1
    buffer_load_dword v119, v10, s[64:67], s92 offen offset:1024 sc1
    s_waitcnt vmcnt(0)
L_vf_39_v:
    v_dot2_u32_u16 v112, v80, s4, v112
    v_dot2_u32_u16 v112, v81, s5, v112
    v_dot2_u32_u16 v112, v82, s6, v112
    v_dot2_u32_u16 v112, v83, s7, v112
    v_dot2_u32_u16 v113, v84, s4, v113
    v_dot2_u32_u16 v113, v85, s5, v113
    v_dot2_u32_u16 v113, v86, s6, v113
    v_dot2_u32_u16 v113, v87, s7, v113
    v_dot2_u32_u16 v114, v88, s4, v114
    v_dot2_u32_u16 v114, v89, s5, v114
    v_dot2_u32_u16 v114, v90, s6, v114
    v_dot2_u32_u16 v114, v91, s7, v114
    v_dot2_u32_u16 v115, v92, s4, v115
    v_dot2_u32_u16 v115, v93, s5, v115
    v_dot2_u32_u16 v115, v94, s6, v115
    v_dot2_u32_u16 v115, v95, s7, v115
    v_dot2_u32_u16 v116, v96, s4, v116
    v_dot2_u32_u16 v116, v97, s5, v116
    v_dot2_u32_u16 v116, v98, s6, v116
    v_dot2_u32_u16 v116, v99, s7, v116
    v_dot2_u32_u16 v117, v100, s4, v117
    v_dot2_u32_u16 v117, v101, s5, v117
    v_dot2_u32_u16 v117, v102, s6, v117
    v_dot2_u32_u16 v117, v103, s7, v117
    v_dot2_u32_u16 v118, v104, s4, v118
    v_dot2_u32_u16 v118, v105, s5, v118
    v_dot2_u32_u16 v118, v106, s6, v118
    v_dot2_u32_u16 v118, v107, s7, v118
    v_dot2_u32_u16 v119, v108, s4, v119
    v_dot2_u32_u16 v119, v109, s5, v119
    v_dot2_u32_u16 v119, v110, s6, v119
    v_dot2_u32_u16 v119, v111, s7, v119
    v_xor_b32 v12, s71, v112
    v_bitop3_b32 v12, v12, v113, s71 bitop3:0xf6
    v_bitop3_b32 v12, v12, v114, s71 bitop3:0xf6
    v_bitop3_b32 v12, v12, v115, s71 bitop3:0xf6
    v_bitop3_b32 v12, v12, v116, s71 bitop3:0xf6
    v_bitop3_b32 v12, v12, v117, s71 bitop3:0xf6
    v_bitop3_b32 v12, v12, v118, s71 bitop3:0xf6
    v_bitop3_b32 v12, v12, v119, s71 bitop3:0xf6
    v_cmp_ne_u32 vcc, 0, v12
    s_cbranch_vccz L_vf_39_d
    s_sleep 4
    s_add_u32 s100, s100, 1
    s_cmp_lt_u32 s100, 60000
    s_cbranch_scc1 L_vf_39
L_vf_39_d:
    s_mov_b32 s86, 0
    ds_read_b64_tr_b16 v[148:149], v8 offset:18432
    ds_read_b64_tr_b16 v[150:151], v8 offset:19456
    ds_read_b64_tr_b16 v[152:153], v14 offset:18432
    ds_read_b64_tr_b16 v[154:155], v14 offset:19456
    s_waitcnt lgkmcnt(8)
    v_mfma_f32_32x32x16_bf16 v[16:31], v[132:135], v[80:83], v[16:31]
    v_mfma_f32_32x32x16_bf16 v[32:47], v[136:139], v[80:83], v[32:47]
    ds_read_b64_tr_b16 v[156:157], v8 offset:26624
    ds_read_b64_tr_b16 v[158:159], v8 offset:27648
    ds_read_b64_tr_b16 v[160:161], v14 offset:26624
    ds_read_b64_tr_b16 v[162:163], v14 offset:27648
    s_waitcnt lgkmcnt(8)
    v_mfma_f32_32x32x16_bf16 v[16:31], v[140:143], v[84:87], v[16:31]
    v_mfma_f32_32x32x16_bf16 v[32:47], v[144:147], v[84:87], v[32:47]
    ds_read_b64_tr_b16 v[132:133], v8 offset:34816
    ds_read_b64_tr_b16 v[134:135], v8 offset:35840
    ds_read_b64_tr_b16 v[136:137], v14 offset:34816
    ds_read_b64_tr_b16 v[138:139], v14 offset:35840
    s_waitcnt lgkmcnt(8)
    v_mfma_f32_32x32x16_bf16 v[16:31], v[148:151], v[88:91], v[16:31]
    v_mfma_f32_32x32x16_bf16 v[32:47], v[152:155], v[88:91], v[32:47]
    ds_read_b64_tr_b16 v[140:141], v8 offset:43008
    ds_read_b64_tr_b16 v[142:143], v8 offset:44032
    ds_read_b64_tr_b16 v[144:145], v14 offset:43008
    ds_read_b64_tr_b16 v[146:147], v14 offset:44032
    s_waitcnt lgkmcnt(8)
    v_mfma_f32_32x32x16_bf16 v[16:31], v[156:159], v[92:95], v[16:31]
    v_mfma_f32_32x32x16_bf16 v[32:47], v[160:163], v[92:95], v[32:47]
    ds_read_b64_tr_b16 v[148:149], v8 offset:51200
    ds_read_b64_tr_b16 v[150:151], v8 offset:52224
    ds_read_b64_tr_b16 v[152:153], v14 offset:51200
    ds_read_b64_tr_b16 v[154:155], v14 offset:52224
    s_waitcnt lgkmcnt(8)
    v_mfma_f32_32x32x16_bf16 v[16:31], v[132:135], v[96:99], v[16:31]
    v_mfma_f32_32x32x16_bf16 v[32:47], v[136:139], v[96:99], v[32:47]
    ds_read_b64_tr_b16 v[156:157], v8 offset:59392
    ds_read_b64_tr_b16 v[158:159], v8 offset:60416
    ds_read_b64_tr_b16 v[160:161], v14 offset:59392
    ds_read_b64_tr_b16 v[162:163], v14 offset:60416
    s_waitcnt lgkmcnt(8)
    v_mfma_f32_32x32x16_bf16 v[16:31], v[140:143], v[100:103], v[16:31]
    v_mfma_f32_32x32x16_bf16 v[32:47], v[144:147], v[100:103], v[32:47]
    s_waitcnt lgkmcnt(4)
    v_mfma_f32_32x32x16_bf16 v[16:31], v[148:151], v[104:107], v[16:31]
    v_mfma_f32_32x32x16_bf16 v[32:47], v[152:155], v[104:107], v[32:47]
    s_waitcnt lgkmcnt(0)
    v_mfma_f32_32x32x16_bf16 v[16:31], v[156:159], v[108:111], v[16:31]
    v_mfma_f32_32x32x16_bf16 v[32:47], v[160:163], v[108:111], v[32:47]
    ds_read_b64_tr_b16 v[132:133], v8 offset:4096
    ds_read_b64_tr_b16 v[134:135], v8 offset:5120
    ds_read_b64_tr_b16 v[136:137], v14 offset:4096
    ds_read_b64_tr_b16 v[138:139], v14 offset:5120
    ds_read_b64_tr_b16 v[140:141], v8 offset:12288
    ds_read_b64_tr_b16 v[142:143], v8 offset:13312
    ds_read_b64_tr_b16 v[144:145], v14 offset:12288
    ds_read_b64_tr_b16 v[146:147], v14 offset:13312
    s_add_u32 s93, s89, 119808
L_hp_40:
    ds_read_b32 v7, v4
    s_waitcnt lgkmcnt(0)
    v_cmp_gt_u32 vcc, s93, v7
    s_cbranch_vccz L_hp_40_d
    s_sleep 8
    s_add_u32 s100, s100, 1
    s_cmp_lt_u32 s100, 60000
    s_cbranch_scc1 L_hp_40
L_hp_40_d:
    s_add_u32 s93, s89, 129024
L_hp_41:
    ds_read_b32 v7, v4
    s_waitcnt lgkmcnt(0)
    v_cmp_gt_u32 vcc, s93, v7
    s_cbranch_vccz L_hp_41_d
    s_sleep 3
    s_add_u32 s100, s100, 1
    s_cmp_lt_u32 s100, 60000
    s_cbranch_scc1 L_hp_41
L_hp_41_d:
    s_add_u32 s92, s82, 20480
    buffer_load_dwordx4 v[80:83], v1, s[64:67], s92 offen sc1
    buffer_load_dword v120, v10, s[64:67], s92 offen offset:1024 sc1
    s_add_u32 s92, s82, 21760
    buffer_load_dwordx4 v[84:87], v1, s[64:67], s92 offen sc1
    buffer_load_dword v121, v10, s[64:67], s92 offen offset:1024 sc1
    s_add_u32 s92, s82, 23040
    buffer_load_dwordx4 v[88:91], v1, s[64:67], s92 offen sc1
    buffer_load_dword v122, v10, s[64:67], s92 offen offset:1024 sc1
    s_add_u32 s92, s82, 24320
    buffer_load_dwordx4 v[92:95], v1, s[64:67], s92 offen sc1
    buffer_load_dword v123, v10, s[64:67], s92 offen offset:1024 sc1
    s_add_u32 s92, s82, 25600
    buffer_load_dwordx4 v[96:99], v1, s[64:67], s92 offen sc1
    buffer_load_dword v124, v10, s[64:67], s92 offen offset:1024 sc1
    s_add_u32 s92, s82, 26880
    buffer_load_dwordx4 v[100:103], v1, s[64:67], s92 offen sc1
    buffer_load_dword v125, v10, s[64:67], s92 offen offset:1024 sc1
    s_add_u32 s92, s82, 28160
    buffer_load_dwordx4 v[104:107], v1, s[64:67], s92 offen sc1
    buffer_load_dword v126, v10, s[64:67], s92 offen offset:1024 sc1
    s_add_u32 s92, s82, 29440
    buffer_load_dwordx4 v[108:111], v1, s[64:67], s92 offen sc1
    buffer_load_dword v127, v10, s[64:67], s92 offen offset:1024 sc1
    s_waitcnt vmcnt(0)
    s_branch L_vf_42_v
L_vf_42:
    s_add_u32 s92, s82, 20480
    buffer_load_dwordx4 v[80:83], v1, s[64:67], s92 offen sc1
    buffer_load_dword v120, v10, s[64:67], s92 offen offset:1024 sc1
    s_add_u32 s92, s82, 21760
    buffer_load_dwordx4 v[84:87], v1, s[64:67], s92 offen sc1
    buffer_load_dword v121, v10, s[64:67], s92 offen offset:1024 sc1
    s_add_u32 s92, s82, 23040
    buffer_load_dwordx4 v[88:91], v1, s[64:67], s92 offen sc1
    buffer_load_dword v122, v10, s[64:67], s92 offen offset:1024 sc1
    s_add_u32 s92, s82, 24320
    buffer_load_dwordx4 v[92:95], v1, s[64:67], s92 offen sc1
    buffer_load_dword v123, v10, s[64:67], s92 offen offset:1024 sc1
    s_add_u32 s92, s82, 25600
    buffer_load_dwordx4 v[96:99], v1, s[64:67], s92 offen sc1
    buffer_load_dword v124, v10, s[64:67], s92 offen offset:1024 sc1
    s_add_u32 s92, s82, 26880
    buffer_load_dwordx4 v[100:103], v1, s[64:67], s92 offen sc1
    buffer_load_dword v125, v10, s[64:67], s92 offen offset:1024 sc1
    s_add_u32 s92, s82, 28160
    buffer_load_dwordx4 v[104:107], v1, s[64:67], s92 offen sc1
    buffer_load_dword v126, v10, s[64:67], s92 offen offset:1024 sc1
    s_add_u32 s92, s82, 29440
    buffer_load_dwordx4 v[108:111], v1, s[64:67], s92 offen sc1
    buffer_load_dword v127, v10, s[64:67], s92 offen offset:1024 sc1
    s_waitcnt vmcnt(0)
L_vf_42_v:
    v_dot2_u32_u16 v120, v80, s4, v120
    v_dot2_u32_u16 v120, v81, s5, v120
    v_dot2_u32_u16 v120, v82, s6, v120
    v_dot2_u32_u16 v120, v83, s7, v120
    v_dot2_u32_u16 v121, v84, s4, v121
    v_dot2_u32_u16 v121, v85, s5, v121
    v_dot2_u32_u16 v121, v86, s6, v121
    v_dot2_u32_u16 v121, v87, s7, v121
    v_dot2_u32_u16 v122, v88, s4, v122
    v_dot2_u32_u16 v122, v89, s5, v122
    v_dot2_u32_u16 v122, v90, s6, v122
    v_dot2_u32_u16 v122, v91, s7, v122
    v_dot2_u32_u16 v123, v92, s4, v123
    v_dot2_u32_u16 v123, v93, s5, v123
    v_dot2_u32_u16 v123, v94, s6, v123
    v_dot2_u32_u16 v123, v95, s7, v123
    v_dot2_u32_u16 v124, v96, s4, v124
    v_dot2_u32_u16 v124, v97, s5, v124
    v_dot2_u32_u16 v124, v98, s6, v124
    v_dot2_u32_u16 v124, v99, s7, v124
    v_dot2_u32_u16 v125, v100, s4, v125
    v_dot2_u32_u16 v125, v101, s5, v125
    v_dot2_u32_u16 v125, v102, s6, v125
    v_dot2_u32_u16 v125, v103, s7, v125
    v_dot2_u32_u16 v126, v104, s4, v126
    v_dot2_u32_u16 v126, v105, s5, v126
    v_dot2_u32_u16 v126, v106, s6, v126
    v_dot2_u32_u16 v126, v107, s7, v126
    v_dot2_u32_u16 v127, v108, s4, v127
    v_dot2_u32_u16 v127, v109, s5, v127
    v_dot2_u32_u16 v127, v110, s6, v127
    v_dot2_u32_u16 v127, v111, s7, v127
    v_xor_b32 v12, s71, v120
    v_bitop3_b32 v12, v12, v121, s71 bitop3:0xf6
    v_bitop3_b32 v12, v12, v122, s71 bitop3:0xf6
    v_bitop3_b32 v12, v12, v123, s71 bitop3:0xf6
    v_bitop3_b32 v12, v12, v124, s71 bitop3:0xf6
    v_bitop3_b32 v12, v12, v125, s71 bitop3:0xf6
    v_bitop3_b32 v12, v12, v126, s71 bitop3:0xf6
    v_bitop3_b32 v12, v12, v127, s71 bitop3:0xf6
    v_cmp_ne_u32 vcc, 0, v12
    s_cbranch_vccz L_vf_42_d
    s_sleep 1
    s_add_u32 s100, s100, 1
    s_cmp_lt_u32 s100, 60000
    s_cbranch_scc1 L_vf_42
L_vf_42_d:
    s_mov_b32 s86, 0
    s_mov_b32 s85, 8388608
    s_add_u32 s82, s83, 8388608
    s_add_u32 s92, s82, 30720
    buffer_load_dwordx4 v[48:51], v1, s[64:67], s92 offen sc1
    buffer_load_dword v112, v10, s[64:67], s92 offen offset:1024 sc1
    s_add_u32 s92, s82, 32000
    buffer_load_dwordx4 v[52:55], v1, s[64:67], s92 offen sc1
    buffer_load_dword v113, v10, s[64:67], s92 offen offset:1024 sc1
    s_add_u32 s92, s82, 33280
    buffer_load_dwordx4 v[56:59], v1, s[64:67], s92 offen sc1
    buffer_load_dword v114, v10, s[64:67], s92 offen offset:1024 sc1
    s_add_u32 s92, s82, 34560
    buffer_load_dwordx4 v[60:63], v1, s[64:67], s92 offen sc1
    buffer_load_dword v115, v10, s[64:67], s92 offen offset:1024 sc1
    s_add_u32 s92, s82, 35840
    buffer_load_dwordx4 v[64:67], v1, s[64:67], s92 offen sc1
    buffer_load_dword v116, v10, s[64:67], s92 offen offset:1024 sc1
    s_add_u32 s92, s82, 37120
    buffer_load_dwordx4 v[68:71], v1, s[64:67], s92 offen sc1
    buffer_load_dword v117, v10, s[64:67], s92 offen offset:1024 sc1
    s_add_u32 s92, s82, 38400
    buffer_load_dwordx4 v[72:75], v1, s[64:67], s92 offen sc1
    buffer_load_dword v118, v10, s[64:67], s92 offen offset:1024 sc1
    s_add_u32 s92, s82, 39680
    buffer_load_dwordx4 v[76:79], v1, s[64:67], s92 offen sc1
    buffer_load_dword v119, v10, s[64:67], s92 offen offset:1024 sc1
    ds_read_b64_tr_b16 v[148:149], v8 offset:20480
    ds_read_b64_tr_b16 v[150:151], v8 offset:21504
    ds_read_b64_tr_b16 v[152:153], v14 offset:20480
    ds_read_b64_tr_b16 v[154:155], v14 offset:21504
    s_waitcnt lgkmcnt(8)
    v_mfma_f32_32x32x16_bf16 v[16:31], v[132:135], v[80:83], v[16:31]
    v_mfma_f32_32x32x16_bf16 v[32:47], v[136:139], v[80:83], v[32:47]
    ds_read_b64_tr_b16 v[156:157], v8 offset:28672
    ds_read_b64_tr_b16 v[158:159], v8 offset:29696
    ds_read_b64_tr_b16 v[160:161], v14 offset:28672
    ds_read_b64_tr_b16 v[162:163], v14 offset:29696
    s_waitcnt lgkmcnt(8)
    v_mfma_f32_32x32x16_bf16 v[16:31], v[140:143], v[84:87], v[16:31]
    v_mfma_f32_32x32x16_bf16 v[32:47], v[144:147], v[84:87], v[32:47]
    ds_read_b64_tr_b16 v[132:133], v8 offset:36864
    ds_read_b64_tr_b16 v[134:135], v8 offset:37888
    ds_read_b64_tr_b16 v[136:137], v14 offset:36864
    ds_read_b64_tr_b16 v[138:139], v14 offset:37888
    s_waitcnt lgkmcnt(8)
    v_mfma_f32_32x32x16_bf16 v[16:31], v[148:151], v[88:91], v[16:31]
    v_mfma_f32_32x32x16_bf16 v[32:47], v[152:155], v[88:91], v[32:47]
    ds_read_b64_tr_b16 v[140:141], v8 offset:45056
    ds_read_b64_tr_b16 v[142:143], v8 offset:46080
    ds_read_b64_tr_b16 v[144:145], v14 offset:45056
    ds_read_b64_tr_b16 v[146:147], v14 offset:46080
    s_waitcnt lgkmcnt(8)
    v_mfma_f32_32x32x16_bf16 v[16:31], v[156:159], v[92:95], v[16:31]
    v_mfma_f32_32x32x16_bf16 v[32:47], v[160:163], v[92:95], v[32:47]
    ds_read_b64_tr_b16 v[148:149], v8 offset:53248
    ds_read_b64_tr_b16 v[150:151], v8 offset:54272
    ds_read_b64_tr_b16 v[152:153], v14 offset:53248
    ds_read_b64_tr_b16 v[154:155], v14 offset:54272
    s_waitcnt lgkmcnt(8)
    v_mfma_f32_32x32x16_bf16 v[16:31], v[132:135], v[96:99], v[16:31]
    v_mfma_f32_32x32x16_bf16 v[32:47], v[136:139], v[96:99], v[32:47]
    ds_read_b64_tr_b16 v[156:157], v8 offset:61440
    ds_read_b64_tr_b16 v[158:159], v8 offset:62464
    ds_read_b64_tr_b16 v[160:161], v14 offset:61440
    ds_read_b64_tr_b16 v[162:163], v14 offset:62464
    s_waitcnt lgkmcnt(8)
    v_mfma_f32_32x32x16_bf16 v[16:31], v[140:143], v[100:103], v[16:31]
    v_mfma_f32_32x32x16_bf16 v[32:47], v[144:147], v[100:103], v[32:47]
    s_waitcnt lgkmcnt(4)
    v_mfma_f32_32x32x16_bf16 v[16:31], v[148:151], v[104:107], v[16:31]
    v_mfma_f32_32x32x16_bf16 v[32:47], v[152:155], v[104:107], v[32:47]
    s_waitcnt lgkmcnt(0)
    v_mfma_f32_32x32x16_bf16 v[16:31], v[156:159], v[108:111], v[16:31]
    v_mfma_f32_32x32x16_bf16 v[32:47], v[160:163], v[108:111], v[32:47]
    ds_read_b64_tr_b16 v[132:133], v8 offset:6144
    ds_read_b64_tr_b16 v[134:135], v8 offset:7168
    ds_read_b64_tr_b16 v[136:137], v14 offset:6144
    ds_read_b64_tr_b16 v[138:139], v14 offset:7168
    ds_read_b64_tr_b16 v[140:141], v8 offset:14336
    ds_read_b64_tr_b16 v[142:143], v8 offset:15360
    ds_read_b64_tr_b16 v[144:145], v14 offset:14336
    ds_read_b64_tr_b16 v[146:147], v14 offset:15360
    s_waitcnt vmcnt(8)
    s_branch L_vf_43_v
L_vf_43:
    s_add_u32 s86, s86, 1
    s_and_b32 s92, s86, 15
    s_cselect_b32 s92, 0, 8388608
    s_xor_b32 s85, s85, s92
    s_add_u32 s82, s83, s85
    s_add_u32 s92, s82, 30720
    buffer_load_dwordx4 v[48:51], v1, s[64:67], s92 offen sc1
    buffer_load_dword v112, v10, s[64:67], s92 offen offset:1024 sc1
    s_add_u32 s92, s82, 32000
    buffer_load_dwordx4 v[52:55], v1, s[64:67], s92 offen sc1
    buffer_load_dword v113, v10, s[64:67], s92 offen offset:1024 sc1
    s_add_u32 s92, s82, 33280
    buffer_load_dwordx4 v[56:59], v1, s[64:67], s92 offen sc1
    buffer_load_dword v114, v10, s[64:67], s92 offen offset:1024 sc1
    s_add_u32 s92, s82, 34560
    buffer_load_dwordx4 v[60:63], v1, s[64:67], s92 offen sc1
    buffer_load_dword v115, v10, s[64:67], s92 offen offset:1024 sc1
    s_waitcnt vmcnt(0)
L_vf_43_v:
    v_dot2_u32_u16 v112, v48, s4, v112
    v_dot2_u32_u16 v112, v49, s5, v112
    v_dot2_u32_u16 v112, v50, s6, v112
    v_dot2_u32_u16 v112, v51, s7, v112
    v_dot2_u32_u16 v113, v52, s4, v113
    v_dot2_u32_u16 v113, v53, s5, v113
    v_dot2_u32_u16 v113, v54, s6, v113
    v_dot2_u32_u16 v113, v55, s7, v113
    v_dot2_u32_u16 v114, v56, s4, v114
    v_dot2_u32_u16 v114, v57, s5, v114
    v_dot2_u32_u16 v114, v58, s6, v114
    v_dot2_u32_u16 v114, v59, s7, v114
    v_dot2_u32_u16 v115, v60, s4, v115
    v_dot2_u32_u16 v115, v61, s5, v115
    v_dot2_u32_u16 v115, v62, s6, v115
    v_dot2_u32_u16 v115, v63, s7, v115
    v_xor_b32 v12, s71, v112
    v_bitop3_b32 v12, v12, v113, s71 bitop3:0xf6
    v_bitop3_b32 v12, v12, v114, s71 bitop3:0xf6
    v_bitop3_b32 v12, v12, v115, s71 bitop3:0xf6
    v_cmp_ne_u32 vcc, 0, v12
    s_cbranch_vccz L_vf_43_d
    s_sleep 0
    s_add_u32 s100, s100, 1
    s_cmp_lt_u32 s100, 60000
    s_cbranch_scc1 L_vf_43
L_vf_43_d:
    s_mov_b32 s86, 0
    ds_read_b64_tr_b16 v[148:149], v8 offset:22528
    ds_read_b64_tr_b16 v[150:151], v8 offset:23552
    ds_read_b64_tr_b16 v[152:153], v14 offset:22528
    ds_read_b64_tr_b16 v[154:155], v14 offset:23552
    s_waitcnt lgkmcnt(8)
    v_mfma_f32_32x32x16_bf16 v[16:31], v[132:135], v[48:51], v[16:31]
    v_mfma_f32_32x32x16_bf16 v[32:47], v[136:139], v[48:51], v[32:47]
    ds_read_b64_tr_b16 v[156:157], v8 offset:30720
    ds_read_b64_tr_b16 v[158:159], v8 offset:31744
    ds_read_b64_tr_b16 v[160:161], v14 offset:30720
    ds_read_b64_tr_b16 v[162:163], v14 offset:31744
    s_waitcnt lgkmcnt(8)
    v_mfma_f32_32x32x16_bf16 v[16:31], v[140:143], v[52:55], v[16:31]
    v_mfma_f32_32x32x16_bf16 v[32:47], v[144:147], v[52:55], v[32:47]
    s_waitcnt lgkmcnt(4)
    v_mfma_f32_32x32x16_bf16 v[16:31], v[148:151], v[56:59], v[16:31]
    v_mfma_f32_32x32x16_bf16 v[32:47], v[152:155], v[56:59], v[32:47]
    s_waitcnt lgkmcnt(0)
    v_mfma_f32_32x32x16_bf16 v[16:31], v[156:159], v[60:63], v[16:31]
    v_mfma_f32_32x32x16_bf16 v[32:47], v[160:163], v[60:63], v[32:47]
    ds_read_b64_tr_b16 v[132:133], v8 offset:38912
    ds_read_b64_tr_b16 v[134:135], v8 offset:39936
    ds_read_b64_tr_b16 v[136:137], v14 offset:38912
    ds_read_b64_tr_b16 v[138:139], v14 offset:39936
    ds_read_b64_tr_b16 v[140:141], v8 offset:47104
    ds_read_b64_tr_b16 v[142:143], v8 offset:48128
    ds_read_b64_tr_b16 v[144:145], v14 offset:47104
    ds_read_b64_tr_b16 v[146:147], v14 offset:48128
    s_waitcnt vmcnt(0)
    s_branch L_vf_44_v
L_vf_44:
    s_add_u32 s86, s86, 1
    s_and_b32 s92, s86, 15
    s_cselect_b32 s92, 0, 8388608
    s_xor_b32 s85, s85, s92
    s_add_u32 s82, s83, s85
    s_add_u32 s92, s82, 35840
    buffer_load_dwordx4 v[64:67], v1, s[64:67], s92 offen sc1
    buffer_load_dword v116, v10, s[64:67], s92 offen offset:1024 sc1
    s_add_u32 s92, s82, 37120
    buffer_load_dwordx4 v[68:71], v1, s[64:67], s92 offen sc1
    buffer_load_dword v117, v10, s[64:67], s92 offen offset:1024 sc1
    s_add_u32 s92, s82, 38400
    buffer_load_dwordx4 v[72:75], v1, s[64:67], s92 offen sc1
    buffer_load_dword v118, v10, s[64:67], s92 offen offset:1024 sc1
    s_add_u32 s92, s82, 39680
    buffer_load_dwordx4 v[76:79], v1, s[64:67], s92 offen sc1
    buffer_load_dword v119, v10, s[64:67], s92 offen offset:1024 sc1
    s_waitcnt vmcnt(0)
L_vf_44_v:
    v_dot2_u32_u16 v116, v64, s4, v116
    v_dot2_u32_u16 v116, v65, s5, v116
    v_dot2_u32_u16 v116, v66, s6, v116
    v_dot2_u32_u16 v116, v67, s7, v116
    v_dot2_u32_u16 v117, v68, s4, v117
    v_dot2_u32_u16 v117, v69, s5, v117
    v_dot2_u32_u16 v117, v70, s6, v117
    v_dot2_u32_u16 v117, v71, s7, v117
    v_dot2_u32_u16 v118, v72, s4, v118
    v_dot2_u32_u16 v118, v73, s5, v118
    v_dot2_u32_u16 v118, v74, s6, v118
    v_dot2_u32_u16 v118, v75, s7, v118
    v_dot2_u32_u16 v119, v76, s4, v119
    v_dot2_u32_u16 v119, v77, s5, v119
    v_dot2_u32_u16 v119, v78, s6, v119
    v_dot2_u32_u16 v119, v79, s7, v119
    v_xor_b32 v12, s71, v116
    v_bitop3_b32 v12, v12, v117, s71 bitop3:0xf6
    v_bitop3_b32 v12, v12, v118, s71 bitop3:0xf6
    v_bitop3_b32 v12, v12, v119, s71 bitop3:0xf6
    v_cmp_ne_u32 vcc, 0, v12
    s_cbranch_vccz L_vf_44_d
    s_sleep 0
    s_add_u32 s100, s100, 1
    s_cmp_lt_u32 s100, 60000
    s_cbranch_scc1 L_vf_44
L_vf_44_d:
    s_mov_b32 s86, 0
    ds_read_b64_tr_b16 v[148:149], v8 offset:55296
    ds_read_b64_tr_b16 v[150:151], v8 offset:56320
    ds_read_b64_tr_b16 v[152:153], v14 offset:55296
    ds_read_b64_tr_b16 v[154:155], v14 offset:56320
    s_waitcnt lgkmcnt(8)
    v_mfma_f32_32x32x16_bf16 v[16:31], v[132:135], v[64:67], v[16:31]
    v_mfma_f32_32x32x16_bf16 v[32:47], v[136:139], v[64:67], v[32:47]
    ds_read_b64_tr_b16 v[156:157], v8 offset:63488
    ds_read_b64_tr_b16 v[158:159], v8 offset:64512
    ds_read_b64_tr_b16 v[160:161], v14 offset:63488
    ds_read_b64_tr_b16 v[162:163], v14 offset:64512
    s_waitcnt lgkmcnt(8)
    v_mfma_f32_32x32x16_bf16 v[16:31], v[140:143], v[68:71], v[16:31]
    v_mfma_f32_32x32x16_bf16 v[32:47], v[144:147], v[68:71], v[32:47]
    s_waitcnt lgkmcnt(4)
    v_mfma_f32_32x32x16_bf16 v[16:31], v[148:151], v[72:75], v[16:31]
    v_mfma_f32_32x32x16_bf16 v[32:47], v[152:155], v[72:75], v[32:47]
    s_waitcnt lgkmcnt(0)
    v_mfma_f32_32x32x16_bf16 v[16:31], v[156:159], v[76:79], v[16:31]
    v_mfma_f32_32x32x16_bf16 v[32:47], v[160:163], v[76:79], v[32:47]
    s_nop 0
    s_nop 0
    s_nop 0
    s_nop 0
    s_nop 0
    s_nop 0
    s_nop 0
    s_nop 0
    s_nop 0
    s_nop 0
    s_nop 0
    v_cvt_pk_bf16_f32 v132, v16, v17
    v_cvt_pk_bf16_f32 v133, v18, v19
    v_cvt_pk_bf16_f32 v134, v20, v21
    v_cvt_pk_bf16_f32 v135, v22, v23
    v_cvt_pk_bf16_f32 v136, v24, v25
    v_cvt_pk_bf16_f32 v137, v26, v27
    v_cvt_pk_bf16_f32 v138, v28, v29
    v_cvt_pk_bf16_f32 v139, v30, v31
    buffer_store_dwordx4 v[132:135], v11, s[60:63], s81 offen offset:0
    buffer_store_dwordx4 v[136:139], v11, s[60:63], s81 offen offset:16
    v_cvt_pk_bf16_f32 v140, v32, v33
    v_cvt_pk_bf16_f32 v141, v34, v35
    v_cvt_pk_bf16_f32 v142, v36, v37
    v_cvt_pk_bf16_f32 v143, v38, v39
    v_cvt_pk_bf16_f32 v144, v40, v41
    v_cvt_pk_bf16_f32 v145, v42, v43
    v_cvt_pk_bf16_f32 v146, v44, v45
    v_cvt_pk_bf16_f32 v147, v46, v47
    buffer_store_dwordx4 v[140:143], v11, s[60:63], s81 offen offset:64
    buffer_store_dwordx4 v[144:147], v11, s[60:63], s81 offen offset:80
    s_xor_b32 s92, s79, 1
    s_or_b32 s92, s2, s92
    s_cbranch_scc1 L_noep
    s_mov_b32 s92, 5373952
    v_mov_b32 v12, 0
    v_mov_b32 v13, s99
    s_mov_b64 exec, 1
    buffer_store_dword v13, v12, s[64:67], s92 offen sc1
    s_mov_b64 exec, -1
L_noep:
    s_endpgm
L_latepub:
    s_add_u32 s96, s79, 4
    s_mov_b32 s78, 1
    s_mul_i32 s92, s96, 9216
    s_add_u32 s92, s92, 64512
L_hp_45:
    ds_read_b32 v7, v4
    s_waitcnt lgkmcnt(0)
    v_cmp_gt_u32 vcc, s92, v7
    s_cbranch_vccz L_hp_45_d
    s_sleep 20
    s_add_u32 s100, s100, 1
    s_cmp_lt_u32 s100, 60000
    s_cbranch_scc1 L_hp_45
L_hp_45_d:
    s_branch L_pub
L_pub_ret1:
    s_cmp_lg_u32 s79, 3
    s_cbranch_scc1 L_lpx
    ds_write_b32 v5, v5 offset:20
    s_waitcnt lgkmcnt(0)
    s_wakeup
L_lpx:
    s_endpgm
L_pub:
    s_mul_i32 s94, s96, 9216
    s_add_u32 s94, s94, 73728
    v_add_u32 v12, s94, v1
    v_add_u32 v13, s94, v3
    s_and_b32 s92, s96, 1
    s_lshl_b32 s92, s92, 2
    s_lshr_b32 s93, s96, 1
    s_add_u32 s92, s92, s93
    s_lshl_b32 s93, s72, 3
    s_add_u32 s92, s92, s93
    s_lshl_b32 s92, s92, 3
    s_add_u32 s92, s92, s73
    s_mul_i32 s95, s92, 1280
    s_add_u32 s95, s95, 2097152
    s_lshl_b32 s97, s101, 3
    s_add_u32 s97, s97, s96
    s_lshl_b32 s97, s97, 7
    s_add_u32 s97, s97, 5767168
    s_mov_b32 s93, 0x7b800000
L_hp_46:
    ds_read_b32 v7, v4
    s_waitcnt lgkmcnt(0)
    v_cmp_gt_u32 vcc, s94, v7
    s_cbranch_vccz L_hp_46_d
    s_sleep 3
    s_add_u32 s100, s100, 1
    s_cmp_lt_u32 s100, 60000
    s_cbranch_scc1 L_hp_46
L_hp_46_d:
    ds_read2st64_b32 v[80:81], v13 offset0:8 offset1:17
    ds_read2st64_b32 v[82:83], v13 offset0:26 offset1:35
    ds_read_b128 v[48:51], v12 offset:0
    ds_read_b128 v[56:59], v12 offset:2304
    ds_read_b128 v[64:67], v12 offset:4608
    ds_read_b128 v[72:75], v12 offset:6912
    ds_read_b128 v[52:55], v12 offset:1024
    ds_read_b128 v[60:63], v12 offset:3328
    ds_read_b128 v[68:71], v12 offset:5632
    ds_read_b128 v[76:79], v12 offset:7936
    s_waitcnt lgkmcnt(8)
    v_pk_add_f32 v[80:81], v[80:81], v[82:83]
    v_add_f32 v82, v80, v81
    v_rcp_f32 v80, v82
    s_waitcnt lgkmcnt(4)
    v_pk_add_f32 v[48:49], v[48:49], v[56:57]
    v_pk_add_f32 v[64:65], v[64:65], v[72:73]
    v_pk_add_f32 v[48:49], v[48:49], v[64:65]
    v_pk_add_f32 v[50:51], v[50:51], v[58:59]
    v_pk_add_f32 v[66:67], v[66:67], v[74:75]
    v_pk_add_f32 v[50:51], v[50:51], v[66:67]
    s_waitcnt lgkmcnt(0)
    v_pk_add_f32 v[52:53], v[52:53], v[60:61]
    v_pk_add_f32 v[68:69], v[68:69], v[76:77]
    v_pk_add_f32 v[52:53], v[52:53], v[68:69]
    v_pk_add_f32 v[54:55], v[54:55], v[62:63]
    v_pk_add_f32 v[70:71], v[70:71], v[78:79]
    v_pk_add_f32 v[54:55], v[54:55], v[70:71]
    v_pk_mul_f32 v[56:57], v[48:49], 0
    v_pk_fma_f32 v[56:57], v[50:51], 0, v[56:57]
    v_pk_fma_f32 v[56:57], v[52:53], 0, v[56:57]
    v_pk_fma_f32 v[56:57], v[54:55], 0, v[56:57]
    v_add_f32 v56, v56, v57
    v_add_f32 v56, v56, v82
    v_cmp_ngt_f32 vcc, s93, v56
    s_cbranch_vccnz L_exact
    v_max3_f32 v56, abs(v48), abs(v49), abs(v50)
    v_max3_f32 v57, abs(v51), abs(v52), abs(v53)
    v_max3_f32 v56, v56, abs(v54), abs(v55)
    v_max_f32 v56, v56, v57
    v_cmp_gt_f32 vcc, 0xb800000, v56
    s_cbranch_vccnz L_exact
L_exact_ret0:
    v_pk_mul_f32 v[48:49], v[48:49], v[80:81] op_sel_hi:[1,0]
    v_pk_mul_f32 v[50:51], v[50:51], v[80:81] op_sel_hi:[1,0]
    v_pk_mul_f32 v[52:53], v[52:53], v[80:81] op_sel_hi:[1,0]
    v_pk_mul_f32 v[54:55], v[54:55], v[80:81] op_sel_hi:[1,0]
    v_cvt_pk_bf16_f32 v164, v48, v49
    v_cvt_pk_bf16_f32 v165, v50, v51
    v_cvt_pk_bf16_f32 v166, v52, v53
    v_cvt_pk_bf16_f32 v167, v54, v55
    s_cmp_ge_u32 s96, 2
    s_cbranch_scc1 L_pub_tag
    buffer_store_dwordx4 v[164:167], v1, s[64:67], s95 offen sc1
    s_waitcnt vmcnt(0)
    v_mov_b32 v12, 0
    v_mov_b32 v13, s71
    s_mov_b64 exec, 1
    buffer_store_dword v13, v12, s[64:67], s97 offen sc1
    s_mov_b64 exec, -1
    s_branch L_pub_x
L_pub_tag:
    v_dot2_u32_u16 v15, v164, s4, 0
    v_dot2_u32_u16 v15, v165, s5, v15
    v_dot2_u32_u16 v15, v166, s6, v15
    v_dot2_u32_u16 v15, v167, s7, v15
    s_nop 0
    s_nop 0
    s_nop 0
    v_sub_u32 v15, s71, v15
    s_cmp_lt_u32 s96, 6
    s_cbranch_scc1 L_pub_nf
    s_add_u32 s92, s95, 8388608
    buffer_store_dwordx4 v[164:167], v1, s[64:67], s92 offen
    buffer_store_dword v15, v10, s[64:67], s92 offen offset:1024
L_pub_nf:
    buffer_store_dwordx4 v[164:167], v1, s[64:67], s95 offen sc1
    buffer_store_dword v15, v10, s[64:67], s95 offen offset:1024 sc1
    v_mov_b32 v12, 0
    v_mov_b32 v13, s71
    s_mov_b64 exec, 1
    buffer_store_dword v13, v12, s[64:67], s97 offen sc1
    s_mov_b64 exec, -1
L_pub_x:
    s_cmp_eq_u32 s78, 0
    s_cbranch_scc1 L_pub_ret0
    s_branch L_pub_ret1
L_codeend:
L_exact:
    s_mov_b32 s84, 1
    s_waitcnt vmcnt(0)
    s_lshl_b32 s92, s96, 10
    s_add_u32 s92, s92, 147456
    v_add_u32 v132, s92, v1
    ds_read_b128 v[84:87], v132
    v_and_b32 v132, 31, v0
    v_cmp_eq_u32 vcc, 16, v132
    v_mov_b32 v133, 0x4f804f80
    v_lshrrev_b32 v134, 5, v0
    v_cndmask_b32 v92, 0, v133, vcc
    v_mov_b32 v93, v92
    v_mov_b32 v94, v92
    v_mov_b32 v95, v92
    v_mov_b32 v96, v92
    v_mov_b32 v97, v92
    v_mov_b32 v98, v92
    v_mov_b32 v99, v92
    v_lshlrev_b32 v134, 8, v134
    v_and_b32 v132, 15, v0
    v_lshl_add_u32 v134, v132, 4, v134
    v_mov_b32 v48, 0
    v_mov_b32 v49, 0
    v_mov_b32 v50, 0
    v_mov_b32 v51, 0
    v_mov_b32 v52, 0
    v_mov_b32 v53, 0
    v_mov_b32 v54, 0
    v_mov_b32 v55, 0
    v_mov_b32 v56, 0
    v_mov_b32 v57, 0
    v_mov_b32 v58, 0
    v_mov_b32 v59, 0
    v_mov_b32 v60, 0
    v_mov_b32 v61, 0
    v_mov_b32 v62, 0
    v_mov_b32 v63, 0
    v_mov_b32 v132, 0xff800000
    s_mov_b32 s92, 5242880
    s_waitcnt lgkmcnt(0)
L_ex1:
    buffer_load_dwordx4 v[88:91], v1, s[64:67], s92 offen sc1
    s_waitcnt vmcnt(0)
    v_mfma_f32_32x32x16_bf16 v[100:115], v[88:91], v[84:87], 0
    s_nop 0
    s_nop 0
    s_nop 0
    s_nop 0
    s_nop 0
    s_nop 0
    s_nop 0
    s_nop 0
    s_nop 0
    s_nop 0
    s_nop 0
    s_nop 0
    v_max3_f32 v132, v132, v100, v101
    v_max3_f32 v132, v132, v102, v103
    v_max3_f32 v132, v132, v104, v105
    v_max3_f32 v132, v132, v106, v107
    v_max3_f32 v132, v132, v108, v109
    v_max3_f32 v132, v132, v110, v111
    v_max3_f32 v132, v132, v112, v113
    v_max3_f32 v132, v132, v114, v115
    s_add_u32 s92, s92, 1024
    s_cmp_lt_u32 s92, 5308416
    s_cbranch_scc1 L_ex1
    v_mov_b32 v133, v132
    s_nop 0
    s_nop 0
    v_permlane32_swap_b32 v132, v133
    s_nop 0
    v_max_f32 v132, v132, v133
    v_sub_f32 v116, 0, v132
    v_sub_f32 v117, 0, v132
    v_sub_f32 v118, 0, v132
    v_sub_f32 v119, 0, v132
    v_sub_f32 v120, 0, v132
    v_sub_f32 v121, 0, v132
    v_sub_f32 v122, 0, v132
    v_sub_f32 v123, 0, v132
    v_sub_f32 v124, 0, v132
    v_sub_f32 v125, 0, v132
    v_sub_f32 v126, 0, v132
    v_sub_f32 v127, 0, v132
    v_sub_f32 v128, 0, v132
    v_sub_f32 v129, 0, v132
    v_sub_f32 v130, 0, v132
    v_sub_f32 v131, 0, v132
    s_mov_b32 s92, 5242880
    s_mov_b32 s93, 5308416
L_ex2:
    buffer_load_dwordx4 v[88:91], v1, s[64:67], s92 offen sc1
    s_mov_b32 exec_lo, 0xffff
    s_mov_b32 exec_hi, 0xffff
    buffer_load_dwordx4 v[92:95], v134, s[64:67], s93 offen sc1
    buffer_load_dwordx4 v[96:99], v134, s[64:67], s93 offen offset:512 sc1
    s_mov_b64 exec, -1
    s_waitcnt vmcnt(0)
    v_mfma_f32_32x32x16_bf16 v[100:115], v[88:91], v[84:87], v[116:131]
    s_nop 0
    s_nop 0
    s_nop 0
    s_nop 0
    s_nop 0
    s_nop 0
    s_nop 0
    s_nop 0
    s_nop 0
    s_nop 0
    s_nop 0
    s_nop 0
    v_exp_f32 v100, v100
    v_exp_f32 v101, v101
    v_exp_f32 v102, v102
    v_exp_f32 v103, v103
    v_exp_f32 v104, v104
    v_exp_f32 v105, v105
    v_exp_f32 v106, v106
    v_exp_f32 v107, v107
    v_exp_f32 v108, v108
    v_exp_f32 v109, v109
    v_exp_f32 v110, v110
    v_exp_f32 v111, v111
    v_exp_f32 v112, v112
    v_exp_f32 v113, v113
    v_exp_f32 v114, v114
    v_exp_f32 v115, v115
    s_nop 0
    v_cvt_pk_bf16_f32 v100, v100, v101
    v_cvt_pk_bf16_f32 v101, v102, v103
    v_cvt_pk_bf16_f32 v102, v104, v105
    v_cvt_pk_bf16_f32 v103, v106, v107
    v_cvt_pk_bf16_f32 v108, v108, v109
    v_cvt_pk_bf16_f32 v109, v110, v111
    v_cvt_pk_bf16_f32 v110, v112, v113
    v_cvt_pk_bf16_f32 v111, v114, v115
    s_nop 0
    s_nop 0
    v_mfma_f32_32x32x16_bf16 v[48:63], v[92:95], v[100:103], v[48:63]
    v_mfma_f32_32x32x16_bf16 v[48:63], v[96:99], v[108:111], v[48:63]
    s_add_u32 s92, s92, 1024
    s_add_u32 s93, s93, 1024
    s_cmp_lt_u32 s92, 5308416
    s_cbranch_scc1 L_ex2
    s_nop 0
    s_nop 0
    s_nop 0
    s_nop 0
    s_nop 0
    s_nop 0
    s_nop 0
    s_nop 0
    s_nop 0
    s_nop 0
    s_nop 0
    s_nop 0
    v_mov_b32 v132, v56
    s_nop 0
    s_nop 0
    v_permlane32_swap_b32 v56, v132
    s_nop 0
    v_rcp_f32 v80, v56
    s_nop 0
    s_branch L_exact_ret0
L_end:
    s_endpgm
.section .rodata,"a"
.p2align 6
.amdhsa_kernel concat_heads__grouped_kv_mqa__sliding_local_dilated__prompt_kernel
  .amdhsa_next_free_vgpr 168
  .amdhsa_next_free_sgpr 102
  .amdhsa_accum_offset 168
  .amdhsa_group_segment_fixed_size 0
  .amdhsa_kernarg_size 88
  .amdhsa_user_sgpr_count 2
  .amdhsa_user_sgpr_kernarg_segment_ptr 1
  .amdhsa_system_sgpr_workgroup_id_x 1
.end_amdhsa_kernel
```
